```python
import torch

def _softmax(x, axis=-1):
    return torch.softmax(x, dim=axis)
def _gelu(x):
    return torch.nn.functional.gelu(x, approximate="tanh")
def _silu(x):
    return torch.nn.functional.silu(x)
def _sigmoid(x):
    return torch.sigmoid(x)
def _layernorm(x, axis=-1, eps=1e-5):
    m = x.mean(dim=axis, keepdim=True)
    v = x.var(dim=axis, keepdim=True, unbiased=False)
    return (x - m) / torch.sqrt(v + eps)
def _scatter_add(tgt, idx, src, axis=0):
    return tgt.clone().index_add_(axis, idx, src)
def _segment_sum(src, seg, n):
    out = torch.zeros((n,) + src.shape[1:], dtype=src.dtype)
    return out.index_add_(0, seg, src)
def _pad(x, pw):
    flat = tuple(v for pair in reversed(pw) for v in pair)
    return torch.nn.functional.pad(x, flat)

kernel_name = 'recurrent_scan__spectral_fnet__glu_gated_geglu__prompt'

def setup_inputs():

    _w = (lambda a: (lambda t: t.to(torch.bfloat16) if t.is_floating_point() else t)(torch.as_tensor(a)))
    def _A_setup():
        B, S, D = 1, 2048, 512
        ns = torch.arange(S)[:, None] * torch.arange(S)[None, :]
        nd = torch.arange(D)[:, None] * torch.arange(D)[None, :]
        Ws_re = torch.cos(-2.0 * torch.pi * ns / S).to(float)
        Ws_im = torch.sin(-2.0 * torch.pi * ns / S).to(float)
        Wd_re = torch.cos(-2.0 * torch.pi * nd / D).to(float)
        Wd_im = torch.sin(-2.0 * torch.pi * nd / D).to(float)
        return {
            "x": _w((lambda *s: torch.randn(*s, dtype=torch.bfloat16) * 0.05)(B, S, D)),
            "dft_seq_re": _w(Ws_re),
            "dft_seq_im": _w(Ws_im),
            "dft_hid_re": _w(Wd_re),
            "dft_hid_im": _w(Wd_im),
        }
    _A_in = _A_setup()

    def _B_setup():
        B, S, Dm, Df = 1, 2048, 512, 1376
        return {
            "x": _w((lambda *s: torch.randn(*s, dtype=torch.bfloat16) * 0.05)(B, S, Dm)),
            "w_gate": _w((lambda *s: torch.randn(*s, dtype=torch.bfloat16) * 0.05)(Dm, Df) * (Dm ** -0.5)),
            "w_up": _w((lambda *s: torch.randn(*s, dtype=torch.bfloat16) * 0.05)(Dm, Df) * (Dm ** -0.5)),
            "w_down": _w((lambda *s: torch.randn(*s, dtype=torch.bfloat16) * 0.05)(Df, Dm) * (Df ** -0.5)),
        }
    _B_in = _B_setup()

    return {
        "A_x": _A_in["x"],
        "A_dft_seq_re": _A_in["dft_seq_re"],
        "A_dft_seq_im": _A_in["dft_seq_im"],
        "A_dft_hid_re": _A_in["dft_hid_re"],
        "A_dft_hid_im": _A_in["dft_hid_im"],
        "B_x": _B_in["x"],
        "B_w_gate": _B_in["w_gate"],
        "B_w_up": _B_in["w_up"],
        "B_w_down": _B_in["w_down"],
    }

def reference(A_x, A_dft_seq_re, A_dft_seq_im, A_dft_hid_re, A_dft_hid_im, B_x, B_w_gate, B_w_up, B_w_down):
    def _A_ref(x, dft_seq_re, dft_seq_im, dft_hid_re, dft_hid_im):
        a = torch.einsum("bsd,ed->bse", x, dft_hid_re)
        b = torch.einsum("bsd,ed->bse", x, dft_hid_im)
        y = torch.einsum("ts,bse->bte", dft_seq_re, a) - torch.einsum("ts,bse->bte", dft_seq_im, b)
        return y

    def _B_ref(x, w_gate, w_up, w_down):
        g = torch.einsum("bsd,df->bsf", x, w_gate)
        u = torch.einsum("bsd,df->bsf", x, w_up)
        h = _gelu(g) * u
        return torch.einsum("bsf,fd->bsd", h, w_down)

    x = A_x
    xn = _layernorm(x, axis=-1)
    s = _A_ref(xn, A_dft_seq_re, A_dft_seq_im, A_dft_hid_re, A_dft_hid_im)
    g = _silu(_B_ref(xn, B_w_gate, B_w_up, B_w_down))
    return x + s * g
```

```asm
; @launch grid=(256,1,1) block=(512,1,1) lds=163840
.amdgcn_target "amdgcn-amd-amdhsa--gfx950"
.text
.globl recurrent_scan__spectral_fnet__glu_gated_geglu__prompt_kernel
.type recurrent_scan__spectral_fnet__glu_gated_geglu__prompt_kernel,@function
    .p2align 8
recurrent_scan__spectral_fnet__glu_gated_geglu__prompt_kernel:
    s_cmp_ge_u32 s2, 256
    s_cbranch_scc1 L_end
    s_load_dwordx2 s[4:5], s[0:1], 0
    s_load_dwordx4 s[12:15], s[0:1], 48
    s_load_dwordx4 s[8:11], s[0:1], 24
    s_load_dwordx2 s[6:7], s[0:1], 64
    s_load_dwordx4 s[76:79], s[0:1], 72
    s_load_dwordx2 s[16:17], s[0:1], 88
    v_and_b32 v1, 63, v0
    v_lshrrev_b32 v3, 6, v0
    s_getpc_b64 s[40:41]
    s_and_b32 s19, s2, 0xf8
    v_and_b32 v2, 7, v1
    v_or_b32 v2, s19, v2
    v_lshlrev_b32 v2, 7, v2
    global_load_dword v54, v2, s[40:41]
    v_readfirstlane_b32 s20, v3
    s_and_b32 s18, s2, 7
    s_bfe_u32 s19, s2, 0x20003
    s_lshr_b32 s81, s2, 5
    s_lshr_b32 s21, s18, 1
    s_lshl_b32 s21, s21, 2
    s_add_u32 s21, s21, s19
    s_lshl_b32 s80, s18, 2
    s_add_u32 s80, s80, s19
    s_and_b32 s18, s18, 1
    s_mul_i32 s22, s18, 7
    s_add_u32 s22, s22, s81
    s_sub_u32 s22, s22, 1
    s_and_b32 s23, s20, 3
    s_lshr_b32 s24, s20, 2
    v_lshrrev_b32 v4, 3, v1
    v_and_b32 v5, 7, v1
    v_lshrrev_b32 v6, 4, v1
    s_movk_i32 s28, 2752
    s_cmp_eq_u32 s81, 0
    s_cbranch_scc1 L_mix
    s_cmp_ge_u32 s20, 4
    s_cbranch_scc1 L_comp
    v_xor_b32 v5, v5, v6
    v_lshlrev_b32 v5, 4, v5
    v_lshl_add_u32 v72, v4, 16, v5
    v_xor_b32 v73, 64, v72
    v_add_u32 v73, 0x7fc00, v73
    v_add_u32 v74, 0xff800, v72
    v_add_u32 v75, 0xff800, v73
    v_mul_u32_u24 v9, 171, v1
    v_lshrrev_b32 v9, 11, v9
    v_mul_u32_u24 v10, 12, v9
    v_sub_u32 v10, v1, v10
    v_mul_u32_u24 v9, s28, v9
    v_lshl_add_u32 v76, v10, 4, v9
    v_add_u32 v8, 64, v1
    v_mul_u32_u24 v9, 171, v8
    v_lshrrev_b32 v9, 11, v9
    v_mul_u32_u24 v10, 12, v9
    v_sub_u32 v10, v8, v10
    v_lshrrev_b32 v11, 2, v9
    v_and_b32 v11, 2, v11
    v_xor_b32 v10, v11, v10
    v_mul_u32_u24 v9, s28, v9
    v_lshl_add_u32 v77, v10, 4, v9
    v_subrev_u32 v77, 1024, v77
    v_add_u32 v8, 128, v1
    v_mul_u32_u24 v9, 171, v8
    v_lshrrev_b32 v9, 11, v9
    v_mul_u32_u24 v10, 12, v9
    v_sub_u32 v10, v8, v10
    v_xor_b32 v10, 2, v10
    v_mul_u32_u24 v9, s28, v9
    v_lshl_add_u32 v78, v10, 4, v9
    v_subrev_u32 v78, 2048, v78
    s_lshl_b32 s25, s21, 1
    s_lshr_b32 s26, s23, 1
    s_add_u32 s25, s25, s26
    s_and_b32 s26, s23, 1
    s_lshl_b32 s26, s26, 5
    s_add_u32 s25, s25, s26
    s_lshl_b32 s25, s25, 10
    s_lshl_b32 s26, s23, 12
    s_mul_i32 s29, s23, 44032
    s_mul_i32 s30, s22, 192
    s_add_u32 s29, s29, s30
    s_mul_i32 s30, s23, 3072
    s_add_u32 s31, s21, s22
    s_and_b32 s31, s31, 1
    s_lshl_b32 s31, s31, 2
    s_waitcnt lgkmcnt(0)
    s_mov_b32 s44, s4
    s_mov_b32 s45, s5
    s_mov_b32 s46, 0x200000
    s_mov_b32 s47, 0x20000
    s_mov_b32 s48, s12
    s_mov_b32 s49, s13
    s_mov_b32 s50, 0x158000
    s_mov_b32 s51, 0x20000
    s_mov_b32 s56, s14
    s_mov_b32 s57, s15
    s_mov_b32 s58, 0x158000
    s_mov_b32 s59, 0x20000
    s_add_u32 s32, s31, 0
    s_and_b32 s32, s32, 7
    s_lshl_b32 s33, s32, 7
    s_add_u32 s33, s33, s25
    s_mul_i32 s32, s32, 176128
    s_add_u32 m0, s26, 24576
    s_add_u32 s32, s32, s29
    buffer_load_dwordx4 v72, s[44:47], s33 offen lds
    buffer_load_dwordx4 v73, s[44:47], s33 offen offset:1024 lds
    buffer_load_dwordx4 v74, s[44:47], s33 offen offset:2048 lds
    buffer_load_dwordx4 v75, s[44:47], s33 offen offset:3072 lds
    s_add_u32 m0, s30, 0
    s_nop 0
    buffer_load_dwordx4 v76, s[48:51], s32 offen lds
    buffer_load_dwordx4 v77, s[48:51], s32 offen offset:1024 lds
    buffer_load_dwordx4 v78, s[48:51], s32 offen offset:2048 lds
    s_add_u32 m0, s30, 12288
    s_nop 0
    buffer_load_dwordx4 v76, s[56:59], s32 offen lds
    buffer_load_dwordx4 v77, s[56:59], s32 offen offset:1024 lds
    buffer_load_dwordx4 v78, s[56:59], s32 offen offset:2048 lds
    s_add_u32 s32, s31, 1
    s_and_b32 s32, s32, 7
    s_lshl_b32 s33, s32, 7
    s_add_u32 s33, s33, s25
    s_mul_i32 s32, s32, 176128
    s_add_u32 m0, s26, 65536
    s_add_u32 s32, s32, s29
    buffer_load_dwordx4 v72, s[44:47], s33 offen lds
    buffer_load_dwordx4 v73, s[44:47], s33 offen offset:1024 lds
    buffer_load_dwordx4 v74, s[44:47], s33 offen offset:2048 lds
    buffer_load_dwordx4 v75, s[44:47], s33 offen offset:3072 lds
    s_add_u32 m0, s30, 40960
    s_nop 0
    buffer_load_dwordx4 v76, s[48:51], s32 offen lds
    buffer_load_dwordx4 v77, s[48:51], s32 offen offset:1024 lds
    buffer_load_dwordx4 v78, s[48:51], s32 offen offset:2048 lds
    s_add_u32 m0, s30, 53248
    s_nop 0
    buffer_load_dwordx4 v76, s[56:59], s32 offen lds
    buffer_load_dwordx4 v77, s[56:59], s32 offen offset:1024 lds
    buffer_load_dwordx4 v78, s[56:59], s32 offen offset:2048 lds
    s_mov_b32 s52, s16
    s_mov_b32 s53, s17
    s_mov_b32 s54, 0xa00000
    s_mov_b32 s55, 0x20000
    s_mov_b32 s88, s78
    s_mov_b32 s89, s79
    s_mov_b32 s90, 0x100
    s_mov_b32 s91, 0x20000
    v_bfe_u32 v8, v1, 4, 1
    s_and_b32 s35, s23, 1
    v_lshl_add_u32 v8, s35, 1, v8
    v_lshlrev_b32 v8, 1, v8
    v_and_b32 v9, 7, v1
    v_xor_b32 v8, v8, v9
    v_lshlrev_b32 v8, 4, v8
    v_lshrrev_b32 v9, 3, v1
    v_lshl_add_u32 v26, v9, 10, v8
    s_lshl_b32 s83, s23, 13
    s_lshl_b32 s35, s81, 7
    s_add_u32 s83, s83, s35
    s_lshl_b32 s92, s23, 10
    s_mov_b32 s84, s6
    s_mov_b32 s85, s7
    s_mov_b32 s86, 0x158000
    s_mov_b32 s87, 0x20000
    v_and_b32 v37, 31, v1
    v_lshlrev_b32 v37, 4, v37
    s_lshl_b32 s35, s23, 9
    v_add_u32 v36, s35, v37
    s_lshr_b32 s63, s25, 1
    s_add_u32 s63, s63, 8650752
    s_setprio 2
    s_waitcnt vmcnt(10)
    s_barrier
    v_lshlrev_b32 v38, 4, v1
    v_add_u32 v38, 122880, v38
    ds_read_b128 v[224:227], v38
    ds_read_b128 v[228:231], v38 offset:1024
    ds_read_b128 v[232:235], v38 offset:2048
    ds_read_b128 v[236:239], v38 offset:3072
    ds_read_b128 v[240:243], v38 offset:4096
    ds_read_b128 v[244:247], v38 offset:5120
    ds_read_b128 v[248:251], v38 offset:6144
    ds_read_b128 v[252:255], v38 offset:7168
    s_add_u32 s32, s31, 2
    s_and_b32 s32, s32, 7
    s_lshl_b32 s33, s32, 7
    s_add_u32 s33, s33, s25
    s_mul_i32 s32, s32, 176128
    s_add_u32 m0, s26, 106496
    s_add_u32 s32, s32, s29
    buffer_load_dwordx4 v72, s[44:47], s33 offen lds
    buffer_load_dwordx4 v73, s[44:47], s33 offen offset:1024 lds
    buffer_load_dwordx4 v74, s[44:47], s33 offen offset:2048 lds
    buffer_load_dwordx4 v75, s[44:47], s33 offen offset:3072 lds
    s_add_u32 m0, s30, 81920
    s_nop 0
    buffer_load_dwordx4 v76, s[48:51], s32 offen lds
    buffer_load_dwordx4 v77, s[48:51], s32 offen offset:1024 lds
    buffer_load_dwordx4 v78, s[48:51], s32 offen offset:2048 lds
    s_add_u32 m0, s30, 94208
    s_nop 0
    buffer_load_dwordx4 v76, s[56:59], s32 offen lds
    buffer_load_dwordx4 v77, s[56:59], s32 offen offset:1024 lds
    buffer_load_dwordx4 v78, s[56:59], s32 offen offset:2048 lds
    s_waitcnt vmcnt(10) lgkmcnt(0)
    s_barrier
    s_add_u32 s32, s31, 3
    s_and_b32 s32, s32, 7
    s_lshl_b32 s33, s32, 7
    s_add_u32 s33, s33, s25
    s_mul_i32 s32, s32, 176128
    s_add_u32 m0, s26, 147456
    s_add_u32 s32, s32, s29
    buffer_load_dwordx4 v72, s[44:47], s33 offen lds
    buffer_load_dwordx4 v73, s[44:47], s33 offen offset:1024 lds
    buffer_load_dwordx4 v74, s[44:47], s33 offen offset:2048 lds
    buffer_load_dwordx4 v75, s[44:47], s33 offen offset:3072 lds
    s_add_u32 m0, s30, 122880
    s_nop 0
    buffer_load_dwordx4 v76, s[48:51], s32 offen lds
    buffer_load_dwordx4 v77, s[48:51], s32 offen offset:1024 lds
    buffer_load_dwordx4 v78, s[48:51], s32 offen offset:2048 lds
    s_add_u32 m0, s30, 135168
    s_nop 0
    buffer_load_dwordx4 v76, s[56:59], s32 offen lds
    buffer_load_dwordx4 v77, s[56:59], s32 offen offset:1024 lds
    buffer_load_dwordx4 v78, s[56:59], s32 offen offset:2048 lds
    v_lshrrev_b32 v16, 4, v1
    v_and_b32 v18, 1, v16
    v_bfe_u32 v20, v1, 3, 1
    v_lshl_add_u32 v20, v18, 1, v20
    v_lshlrev_b32 v20, 5, v20
    v_bfe_u32 v21, v1, 2, 2
    v_lshl_add_u32 v20, v21, 7, v20
    v_and_b32 v21, 3, v1
    v_lshl_add_u32 v20, v21, 3, v20
    v_lshl_add_u32 v2, v16, 10, v20
    s_and_b32 s35, s23, 1
    s_lshl_b32 s35, s35, 12
    v_add_u32 v2, s35, v2
    v_xor_b32 v3, 32, v2
    v_xor_b32 v4, 64, v2
    v_xor_b32 v5, 96, v2
    v_add_u32 v6, 0xc000, v2
    v_add_u32 v7, 0xc000, v3
    v_add_u32 v8, 0xc000, v4
    v_add_u32 v9, 0xc000, v5
    v_add_u32 v10, 0x18000, v2
    v_add_u32 v11, 0x18000, v3
    v_add_u32 v12, 0x18000, v4
    v_add_u32 v13, 0x18000, v5
    s_lshr_b32 s69, s23, 1
    s_and_b32 s27, s23, 1
    v_and_b32 v17, 15, v1
    v_lshrrev_b32 v19, 1, v16
    s_lshl_b32 s38, s69, 5
    s_add_u32 s38, s38, s80
    s_lshl_b32 s35, s27, 10
    s_add_u32 s38, s38, s35
    s_lshl_b32 s38, s38, 10
    s_lshl_b32 s35, s81, 7
    s_add_u32 s38, s38, s35
    v_lshlrev_b32 v21, 5, v18
    v_lshl_add_u32 v21, v19, 4, v21
    v_lshl_add_u32 v15, v17, 16, v21
    v_lshlrev_b32 v21, 4, v17
    v_lshl_add_u32 v14, v16, 9, v21
    s_lshl_b32 s35, s27, 8
    v_add_u32 v14, s35, v14
    v_xor_b32 v68, 0x100, v14
    s_mov_b32 s36, 0xffff0000
    s_mov_b32 s34, 0xbfb8aa3b
    s_lshl_b32 s35, s20, 11
    s_add_u32 s35, s35, 53248
    v_lshl_add_u32 v25, v1, 4, s35
    s_xor_b32 s35, s20, 1
    s_lshl_b32 s35, s35, 11
    s_add_u32 s35, s35, 53248
    v_lshl_add_u32 v24, v1, 4, s35
    v_add_u32 v69, 8192, v25
    v_add_u32 v70, 8192, v24
    s_lshl_b32 s35, s23, 11
    s_add_u32 s35, s35, 155648
    v_lshl_add_u32 v23, v1, 3, s35
    v_and_b32 v21, 7, v1
    v_xor_b32 v20, v19, v21
    v_lshlrev_b32 v20, 4, v20
    v_lshl_add_u32 v20, v18, 3, v20
    v_lshl_add_u32 v20, v17, 7, v20
    s_mul_i32 s40, s69, 151552
    s_lshl_b32 s35, s27, 11
    s_add_u32 s40, s40, s35
    v_add_u32 v18, s40, v20
    v_xor_b32 v19, 32, v18
    s_and_b32 s35, s81, 1
    s_lshl_b32 s35, s35, 1
    s_sub_i32 s35, 1, s35
    v_lshl_add_u32 v22, s23, 4, v17
    v_cmp_eq_u32 s[42:43], 0, v22
    v_mul_i32_i24 v22, s35, v22
    v_and_b32 v22, 63, v22
    v_lshlrev_b32 v22, 2, v22
    v_lshl_add_u32 v27, v16, 10, v22
    v_lshlrev_b32 v61, 4, v17
    v_lshl_add_u32 v61, v16, 10, v61
    v_lshlrev_b32 v62, 10, v17
    v_lshlrev_b32 v63, 4, v16
    v_lshrrev_b32 v20, 3, v1
    v_xor_b32 v21, v20, v21
    v_lshlrev_b32 v21, 4, v21
    v_lshl_add_u32 v20, v20, 16, v21
    s_add_u32 s37, s38, 523264
    s_mov_b32 s65, 8519680
    v_lshrrev_b32 v60, 1, v1
    v_lshlrev_b32 v60, 7, v60
    v_and_b32 v21, 1, v1
    v_lshl_add_u32 v60, v21, 3, v60
    s_lshl_b32 s35, s23, 9
    s_add_u32 s35, s35, 155648
    v_lshl_add_u32 v22, v1, 3, s35
    s_waitcnt vmcnt(10)
    s_barrier
    s_add_u32 s32, s31, 4
    s_and_b32 s32, s32, 7
    s_lshl_b32 s33, s32, 7
    s_add_u32 s33, s33, s25
    s_mul_i32 s32, s32, 176128
    s_add_u32 m0, s26, 24576
    s_add_u32 s32, s32, s29
    buffer_load_dwordx4 v72, s[44:47], s33 offen lds
    buffer_load_dwordx4 v73, s[44:47], s33 offen offset:1024 lds
    buffer_load_dwordx4 v74, s[44:47], s33 offen offset:2048 lds
    buffer_load_dwordx4 v75, s[44:47], s33 offen offset:3072 lds
    s_add_u32 m0, s30, 0
    s_nop 0
    buffer_load_dwordx4 v76, s[48:51], s32 offen lds
    buffer_load_dwordx4 v77, s[48:51], s32 offen offset:1024 lds
    buffer_load_dwordx4 v78, s[48:51], s32 offen offset:2048 lds
    s_add_u32 m0, s30, 12288
    s_nop 0
    buffer_load_dwordx4 v76, s[56:59], s32 offen lds
    buffer_load_dwordx4 v77, s[56:59], s32 offen offset:1024 lds
    buffer_load_dwordx4 v78, s[56:59], s32 offen offset:2048 lds
    s_waitcnt vmcnt(10)
    s_barrier
    s_add_u32 s32, s31, 5
    s_and_b32 s32, s32, 7
    s_lshl_b32 s33, s32, 7
    s_add_u32 s33, s33, s25
    s_mul_i32 s32, s32, 176128
    s_add_u32 m0, s26, 65536
    s_add_u32 s32, s32, s29
    buffer_load_dwordx4 v72, s[44:47], s33 offen lds
    buffer_load_dwordx4 v73, s[44:47], s33 offen offset:1024 lds
    buffer_load_dwordx4 v74, s[44:47], s33 offen offset:2048 lds
    buffer_load_dwordx4 v75, s[44:47], s33 offen offset:3072 lds
    s_add_u32 m0, s30, 40960
    s_nop 0
    buffer_load_dwordx4 v76, s[48:51], s32 offen lds
    buffer_load_dwordx4 v77, s[48:51], s32 offen offset:1024 lds
    buffer_load_dwordx4 v78, s[48:51], s32 offen offset:2048 lds
    s_add_u32 m0, s30, 53248
    s_nop 0
    buffer_load_dwordx4 v76, s[56:59], s32 offen lds
    buffer_load_dwordx4 v77, s[56:59], s32 offen offset:1024 lds
    buffer_load_dwordx4 v78, s[56:59], s32 offen offset:2048 lds
    s_waitcnt vmcnt(10)
    s_barrier
    s_add_u32 s32, s31, 6
    s_and_b32 s32, s32, 7
    s_lshl_b32 s33, s32, 7
    s_add_u32 s33, s33, s25
    s_mul_i32 s32, s32, 176128
    s_add_u32 m0, s26, 106496
    s_add_u32 s32, s32, s29
    buffer_load_dwordx4 v72, s[44:47], s33 offen lds
    buffer_load_dwordx4 v73, s[44:47], s33 offen offset:1024 lds
    buffer_load_dwordx4 v74, s[44:47], s33 offen offset:2048 lds
    buffer_load_dwordx4 v75, s[44:47], s33 offen offset:3072 lds
    s_add_u32 m0, s30, 81920
    s_nop 0
    buffer_load_dwordx4 v76, s[48:51], s32 offen lds
    buffer_load_dwordx4 v77, s[48:51], s32 offen offset:1024 lds
    buffer_load_dwordx4 v78, s[48:51], s32 offen offset:2048 lds
    s_add_u32 m0, s30, 94208
    s_nop 0
    buffer_load_dwordx4 v76, s[56:59], s32 offen lds
    buffer_load_dwordx4 v77, s[56:59], s32 offen offset:1024 lds
    buffer_load_dwordx4 v78, s[56:59], s32 offen offset:2048 lds
    s_waitcnt vmcnt(10)
    s_barrier
    s_add_u32 s32, s31, 7
    s_and_b32 s32, s32, 7
    s_lshl_b32 s33, s32, 7
    s_add_u32 s33, s33, s25
    s_mul_i32 s32, s32, 176128
    s_add_u32 m0, s26, 147456
    s_add_u32 s32, s32, s29
    buffer_load_dwordx4 v72, s[44:47], s33 offen lds
    buffer_load_dwordx4 v73, s[44:47], s33 offen offset:1024 lds
    buffer_load_dwordx4 v74, s[44:47], s33 offen offset:2048 lds
    buffer_load_dwordx4 v75, s[44:47], s33 offen offset:3072 lds
    s_add_u32 m0, s30, 122880
    s_nop 0
    buffer_load_dwordx4 v76, s[48:51], s32 offen lds
    buffer_load_dwordx4 v77, s[48:51], s32 offen offset:1024 lds
    buffer_load_dwordx4 v78, s[48:51], s32 offen offset:2048 lds
    s_add_u32 m0, s30, 135168
    s_nop 0
    buffer_load_dwordx4 v76, s[56:59], s32 offen lds
    buffer_load_dwordx4 v77, s[56:59], s32 offen offset:1024 lds
    buffer_load_dwordx4 v78, s[56:59], s32 offen offset:2048 lds
    s_waitcnt vmcnt(10)
    s_barrier
    buffer_load_dword v53, off, s[88:91], 0
    buffer_load_dwordx4 v[32:35], v37, s[52:55], s63 offen
    s_add_u32 m0, s92, 4096
    s_add_u32 s35, s83, 0
    buffer_load_dwordx4 v26, s[84:87], s35 offen lds
    s_add_u32 m0, s92, 8192
    s_add_u32 s35, s83, 32768
    buffer_load_dwordx4 v26, s[84:87], s35 offen lds
    s_add_u32 m0, s92, 12288
    s_add_u32 s35, s83, 65536
    buffer_load_dwordx4 v26, s[84:87], s35 offen lds
    s_add_u32 m0, s92, 16384
    s_add_u32 s35, s83, 98304
    buffer_load_dwordx4 v26, s[84:87], s35 offen lds
    s_add_u32 m0, s92, 20480
    s_add_u32 s35, s83, 131072
    buffer_load_dwordx4 v26, s[84:87], s35 offen lds
    s_add_u32 m0, s92, 24576
    s_add_u32 s35, s83, 163840
    buffer_load_dwordx4 v26, s[84:87], s35 offen lds
    s_add_u32 m0, s92, 28672
    s_add_u32 s35, s83, 196608
    buffer_load_dwordx4 v26, s[84:87], s35 offen lds
    s_add_u32 m0, s92, 32768
    s_add_u32 s35, s83, 229376
    buffer_load_dwordx4 v26, s[84:87], s35 offen lds
    s_waitcnt vmcnt(8)
    v_readfirstlane_b32 s41, v53
    s_nop 3
    s_cmp_eq_u32 s41, 0
    s_cbranch_scc1 L_tslow_s
L_tok_s:
    v_xor_b32 v44, s41, v33
    v_xor_b32 v45, s41, v35
    v_or_b32 v44, v44, v45
    v_cmp_ne_u32 vcc, 0, v44
    s_nop 3
    s_cmp_lg_u64 vcc, 0
    s_cbranch_scc1 L_sslow
L_sok:
    v_mov_b32 v40, v32
    v_mov_b32 v41, v34
    v_rsq_f32 v44, v41
    s_nop 0
    v_mul_f32 v43, 0xc0135761, v44
    v_mul_f32 v42, v44, v44
    v_mul_f32 v42, v42, v43
    v_mul_f32 v42, 0x3d372713, v42
    ds_write_b128 v36, v[40:43]
    s_waitcnt vmcnt(10)
    s_barrier
    v_mov_b32 v44, 122876
    ds_write_b32 v44, v53
    s_add_u32 m0, s92, 36864
    s_add_u32 s35, s83, 262144
    buffer_load_dwordx4 v26, s[84:87], s35 offen lds
    s_add_u32 m0, s92, 40960
    s_add_u32 s35, s83, 294912
    buffer_load_dwordx4 v26, s[84:87], s35 offen lds
    s_add_u32 m0, s92, 45056
    s_add_u32 s35, s83, 327680
    buffer_load_dwordx4 v26, s[84:87], s35 offen lds
    s_add_u32 m0, s92, 49152
    s_add_u32 s35, s83, 360448
    buffer_load_dwordx4 v26, s[84:87], s35 offen lds
    s_add_u32 m0, s92, 53248
    s_add_u32 s35, s83, 393216
    buffer_load_dwordx4 v26, s[84:87], s35 offen lds
    s_add_u32 m0, s92, 57344
    s_add_u32 s35, s83, 425984
    buffer_load_dwordx4 v26, s[84:87], s35 offen lds
    s_add_u32 m0, s92, 61440
    s_add_u32 s35, s83, 458752
    buffer_load_dwordx4 v26, s[84:87], s35 offen lds
    s_add_u32 m0, s92, 65536
    s_add_u32 s35, s83, 491520
    buffer_load_dwordx4 v26, s[84:87], s35 offen lds
    s_add_u32 m0, s92, 69632
    s_add_u32 s35, s83, 524288
    buffer_load_dwordx4 v26, s[84:87], s35 offen lds
    s_add_u32 m0, s92, 73728
    s_add_u32 s35, s83, 557056
    buffer_load_dwordx4 v26, s[84:87], s35 offen lds
    s_waitcnt lgkmcnt(0)
    s_setprio 0
    s_barrier
    s_add_u32 m0, s92, 77824
    s_add_u32 s35, s83, 589824
    buffer_load_dwordx4 v26, s[84:87], s35 offen lds
    s_add_u32 m0, s92, 81920
    s_add_u32 s35, s83, 622592
    buffer_load_dwordx4 v26, s[84:87], s35 offen lds
    s_add_u32 m0, s92, 86016
    s_add_u32 s35, s83, 655360
    buffer_load_dwordx4 v26, s[84:87], s35 offen lds
    s_add_u32 m0, s92, 90112
    s_add_u32 s35, s83, 688128
    buffer_load_dwordx4 v26, s[84:87], s35 offen lds
    s_add_u32 m0, s92, 94208
    s_add_u32 s35, s83, 720896
    buffer_load_dwordx4 v26, s[84:87], s35 offen lds
    s_add_u32 m0, s92, 98304
    s_add_u32 s35, s83, 753664
    buffer_load_dwordx4 v26, s[84:87], s35 offen lds
    s_add_u32 m0, s92, 102400
    s_add_u32 s35, s83, 786432
    buffer_load_dwordx4 v26, s[84:87], s35 offen lds
    s_add_u32 m0, s92, 106496
    s_add_u32 s35, s83, 819200
    buffer_load_dwordx4 v26, s[84:87], s35 offen lds
    s_lshl_b32 s26, s69, 5
    s_add_u32 s26, s26, s80
    s_mul_i32 s26, s26, 88064
    s_lshl_b32 s35, s27, 11
    s_add_u32 s26, s26, s35
    s_add_u32 s26, s26, 4096
    s_add_u32 s30, s26, 81920
    s_mov_b32 s56, s76
    s_mov_b32 s57, s77
    s_mov_b32 s58, 0x200000
    s_mov_b32 s59, 0x20000
    s_lshl_b32 s35, s81, 2
    s_lshr_b32 s35, 0x43dae170, s35
    s_and_b32 s31, s35, 3
    s_bfe_u32 s32, s35, 0x20002
    s_sub_u32 s33, 32, s80
    s_and_b32 s33, s33, 31
    s_cmp_ge_u32 s81, 4
    s_cselect_b32 s33, s33, s80
    s_lshl_b32 s33, s33, 2
    s_add_u32 s33, s33, s23
    s_lshl_b32 s33, s33, 14
    s_add_u32 s33, s33, 6291456
    s_lshl_b32 s32, s32, 8
    s_add_u32 s32, s32, s33
    s_cmp_eq_u32 s81, 0
    s_cselect_b32 s32, 0x40000000, s32
    s_lshl_b32 s31, s31, 8
    s_add_u32 s33, s33, s31
    s_waitcnt vmcnt(14)
    s_barrier
    s_add_u32 m0, s92, 110592
    s_add_u32 s35, s83, 851968
    buffer_load_dwordx4 v26, s[84:87], s35 offen lds
    s_add_u32 m0, s92, 114688
    s_add_u32 s35, s83, 884736
    buffer_load_dwordx4 v26, s[84:87], s35 offen lds
    s_add_u32 m0, s92, 118784
    s_add_u32 s35, s83, 917504
    buffer_load_dwordx4 v26, s[84:87], s35 offen lds
    s_add_u32 m0, s92, 122880
    s_add_u32 s35, s83, 950272
    buffer_load_dwordx4 v26, s[84:87], s35 offen lds
    s_add_u32 m0, s92, 126976
    s_add_u32 s35, s83, 983040
    buffer_load_dwordx4 v26, s[84:87], s35 offen lds
    s_add_u32 m0, s92, 131072
    s_add_u32 s35, s83, 1015808
    buffer_load_dwordx4 v26, s[84:87], s35 offen lds
    s_add_u32 m0, s92, 135168
    s_add_u32 s35, s83, 1048576
    buffer_load_dwordx4 v26, s[84:87], s35 offen lds
    s_add_u32 m0, s92, 139264
    s_add_u32 s35, s83, 1081344
    buffer_load_dwordx4 v26, s[84:87], s35 offen lds
    s_add_u32 m0, s92, 143360
    s_add_u32 s35, s83, 1114112
    buffer_load_dwordx4 v26, s[84:87], s35 offen lds
    s_add_u32 m0, s92, 147456
    s_add_u32 s35, s83, 1146880
    buffer_load_dwordx4 v26, s[84:87], s35 offen lds
    ds_read_b64_tr_b16 v[120:121], v2 offset:4096
    ds_read_b64_tr_b16 v[122:123], v2 offset:4608
    ds_read_b64_tr_b16 v[124:125], v3 offset:4096
    ds_read_b64_tr_b16 v[126:127], v3 offset:4608
    ds_read_b64_tr_b16 v[128:129], v4 offset:4096
    ds_read_b64_tr_b16 v[130:131], v4 offset:4608
    ds_read_b64_tr_b16 v[132:133], v5 offset:4096
    ds_read_b64_tr_b16 v[134:135], v5 offset:4608
    ds_read_b64_tr_b16 v[136:137], v2 offset:20480
    ds_read_b64_tr_b16 v[138:139], v2 offset:20992
    ds_read_b64_tr_b16 v[140:141], v3 offset:20480
    ds_read_b64_tr_b16 v[142:143], v3 offset:20992
    ds_read_b64_tr_b16 v[144:145], v4 offset:20480
    ds_read_b64_tr_b16 v[146:147], v4 offset:20992
    ds_read_b64_tr_b16 v[148:149], v5 offset:20480
    ds_read_b64_tr_b16 v[150:151], v5 offset:20992
    ds_read_b64_tr_b16 v[152:153], v2 offset:36864
    ds_read_b64_tr_b16 v[154:155], v2 offset:37376
    ds_read_b64_tr_b16 v[156:157], v3 offset:36864
    ds_read_b64_tr_b16 v[158:159], v3 offset:37376
    ds_read_b64_tr_b16 v[160:161], v4 offset:36864
    ds_read_b64_tr_b16 v[162:163], v4 offset:37376
    ds_read_b64_tr_b16 v[164:165], v5 offset:36864
    ds_read_b64_tr_b16 v[166:167], v5 offset:37376
L_p2h:
    s_waitcnt vmcnt(0) lgkmcnt(0)
L_p2h1:
    s_barrier
    buffer_load_dwordx2 v[28:29], v60, s[52:55], s65 offen
    s_mov_b32 m0, s40
    s_nop 0
    buffer_load_dwordx4 v20, s[44:47], s38 offen lds
    buffer_load_dwordx4 v20, s[44:47], s37 offen offset:1024 lds
    s_add_u32 m0, s92, 4096
    s_add_u32 s35, s83, 1179648
    buffer_load_dwordx4 v26, s[84:87], s35 offen lds
    s_add_u32 m0, s92, 8192
    s_add_u32 s35, s83, 1212416
    buffer_load_dwordx4 v26, s[84:87], s35 offen lds
    s_add_u32 m0, s92, 12288
    s_add_u32 s35, s83, 1245184
    buffer_load_dwordx4 v26, s[84:87], s35 offen lds
    s_add_u32 m0, s92, 16384
    s_add_u32 s35, s83, 1277952
    buffer_load_dwordx4 v26, s[84:87], s35 offen lds
    s_add_u32 m0, s92, 20480
    s_add_u32 s35, s83, 1310720
    buffer_load_dwordx4 v26, s[84:87], s35 offen lds
    s_add_u32 m0, s92, 24576
    s_add_u32 s35, s83, 1343488
    buffer_load_dwordx4 v26, s[84:87], s35 offen lds
    s_add_u32 m0, s92, 28672
    s_add_u32 s35, s83, 1376256
    buffer_load_dwordx4 v26, s[84:87], s35 offen lds
    ds_read_b64_tr_b16 v[168:169], v6 offset:4096
    ds_read_b64_tr_b16 v[170:171], v6 offset:4608
    ds_read_b64_tr_b16 v[172:173], v7 offset:4096
    ds_read_b64_tr_b16 v[174:175], v7 offset:4608
    ds_read_b64_tr_b16 v[176:177], v8 offset:4096
    ds_read_b64_tr_b16 v[178:179], v8 offset:4608
    ds_read_b64_tr_b16 v[180:181], v9 offset:4096
    ds_read_b64_tr_b16 v[182:183], v9 offset:4608
    ds_read_b64_tr_b16 v[184:185], v6 offset:20480
    ds_read_b64_tr_b16 v[186:187], v6 offset:20992
    ds_read_b64_tr_b16 v[188:189], v7 offset:20480
    ds_read_b64_tr_b16 v[190:191], v7 offset:20992
    ds_read_b64_tr_b16 v[192:193], v8 offset:20480
    ds_read_b64_tr_b16 v[194:195], v8 offset:20992
    ds_read_b64_tr_b16 v[196:197], v9 offset:20480
    ds_read_b64_tr_b16 v[198:199], v9 offset:20992
    ds_read_b64_tr_b16 v[200:201], v6 offset:36864
    ds_read_b64_tr_b16 v[202:203], v6 offset:37376
    ds_read_b64_tr_b16 v[204:205], v7 offset:36864
    ds_read_b64_tr_b16 v[206:207], v7 offset:37376
    ds_read_b64_tr_b16 v[208:209], v8 offset:36864
    ds_read_b64_tr_b16 v[210:211], v8 offset:37376
    ds_read_b64_tr_b16 v[212:213], v9 offset:36864
    ds_read_b64_tr_b16 v[214:215], v9 offset:37376
    s_waitcnt vmcnt(9)
    v_xor_b32 v28, s41, v28
    v_xor_b32 v29, s41, v29
    v_or_b32 v28, v28, v29
    v_cmp_ne_u32 vcc, 0, v28
    s_lshl_b32 s35, s23, 12
    s_add_u32 m0, s35, 36864
    s_nop 2
    s_cmp_lg_u64 vcc, 0
    s_cbranch_scc1 L_gslow
L_gok:
    s_add_u32 s35, s33, 0
    buffer_load_dwordx4 v61, s[52:55], s35 offen sc1 lds
    s_add_u32 s35, s33, 3072
    buffer_load_dwordx4 v61, s[52:55], s35 offen offset:1024 sc1 lds
    s_add_u32 s35, s33, 6144
    buffer_load_dwordx4 v61, s[52:55], s35 offen offset:2048 sc1 lds
    s_add_u32 s35, s33, 9216
    buffer_load_dwordx4 v61, s[52:55], s35 offen offset:3072 sc1 lds
    s_lshl_b32 s35, s23, 8
    s_add_u32 m0, s35, 32768
    s_nop 0
    buffer_load_dword v62, s[52:55], s32 offen sc1 lds
    s_waitcnt lgkmcnt(0)
    s_barrier
    s_add_u32 s35, s26, 0
    buffer_load_dwordx4 v[72:75], v14, s[52:55], s35 offen sc1
    buffer_load_dwordx4 v[76:79], v68, s[52:55], s35 offen sc1
    s_add_u32 s35, s26, 8192
    buffer_load_dwordx4 v[80:83], v14, s[52:55], s35 offen sc1
    buffer_load_dwordx4 v[84:87], v68, s[52:55], s35 offen sc1
    s_add_u32 s35, s26, 16384
    buffer_load_dwordx4 v[88:91], v14, s[52:55], s35 offen sc1
    buffer_load_dwordx4 v[92:95], v68, s[52:55], s35 offen sc1
    s_waitcnt vmcnt(6)
    s_barrier
    ds_read_b32 v104, v27 offset:36864
    ds_read_b32 v105, v27 offset:37120
    ds_read_b32 v106, v27 offset:37376
    ds_read_b32 v107, v27 offset:37632
    ds_read_b32 v108, v27 offset:40960
    ds_read_b32 v109, v27 offset:41216
    ds_read_b32 v110, v27 offset:41472
    ds_read_b32 v111, v27 offset:41728
    ds_read_b32 v112, v27 offset:45056
    ds_read_b32 v113, v27 offset:45312
    ds_read_b32 v114, v27 offset:45568
    ds_read_b32 v115, v27 offset:45824
    ds_read_b32 v116, v27 offset:49152
    ds_read_b32 v117, v27 offset:49408
    ds_read_b32 v118, v27 offset:49664
    ds_read_b32 v119, v27 offset:49920
    s_mov_b64 exec, s[42:43]
    ds_read_b128 v[104:107], v63 offset:32768
    ds_read_b128 v[108:111], v63 offset:33024
    ds_read_b128 v[112:115], v63 offset:33280
    ds_read_b128 v[116:119], v63 offset:33536
    s_mov_b64 exec, -1
    s_waitcnt lgkmcnt(0)
    v_mfma_f32_16x16x32_bf16 v[28:31], v[104:107], v[224:227], 0
    v_mfma_f32_16x16x32_bf16 v[36:39], v[104:107], v[240:243], 0
    v_mfma_f32_16x16x32_bf16 v[28:31], v[108:111], v[228:231], v[28:31]
    v_mfma_f32_16x16x32_bf16 v[36:39], v[108:111], v[244:247], v[36:39]
    v_mfma_f32_16x16x32_bf16 v[28:31], v[112:115], v[232:235], v[28:31]
    v_mfma_f32_16x16x32_bf16 v[36:39], v[112:115], v[248:251], v[36:39]
    v_mfma_f32_16x16x32_bf16 v[28:31], v[116:119], v[236:239], v[28:31]
    v_mfma_f32_16x16x32_bf16 v[36:39], v[116:119], v[252:255], v[36:39]
    v_xor_b32 v105, 0x80008000, v105
    v_xor_b32 v107, 0x80008000, v107
    v_xor_b32 v109, 0x80008000, v109
    v_xor_b32 v111, 0x80008000, v111
    v_xor_b32 v113, 0x80008000, v113
    v_xor_b32 v115, 0x80008000, v115
    v_xor_b32 v117, 0x80008000, v117
    v_xor_b32 v119, 0x80008000, v119
    s_nop 1
    v_mfma_f32_16x16x32_bf16 v[32:35], v[104:107], v[224:227], 0
    v_mfma_f32_16x16x32_bf16 v[40:43], v[104:107], v[240:243], 0
    v_mfma_f32_16x16x32_bf16 v[32:35], v[108:111], v[228:231], v[32:35]
    v_mfma_f32_16x16x32_bf16 v[40:43], v[108:111], v[244:247], v[40:43]
    v_mfma_f32_16x16x32_bf16 v[32:35], v[112:115], v[232:235], v[32:35]
    v_mfma_f32_16x16x32_bf16 v[40:43], v[112:115], v[248:251], v[40:43]
    v_mfma_f32_16x16x32_bf16 v[32:35], v[116:119], v[236:239], v[32:35]
    v_mfma_f32_16x16x32_bf16 v[40:43], v[116:119], v[252:255], v[40:43]
    s_nop 3
    v_cvt_pk_bf16_f32 v224, v28, v29
    v_cvt_pk_bf16_f32 v225, v30, v31
    v_cvt_pk_bf16_f32 v228, v36, v37
    v_cvt_pk_bf16_f32 v229, v38, v39
    v_cvt_pk_bf16_f32 v226, v32, v33
    v_cvt_pk_bf16_f32 v227, v34, v35
    v_cvt_pk_bf16_f32 v230, v40, v41
    v_cvt_pk_bf16_f32 v231, v42, v43
    ds_write_b64 v22, v[224:225]
    ds_write_b64 v22, v[226:227] offset:2048
    ds_write_b64 v22, v[228:229] offset:4096
    ds_write_b64 v22, v[230:231] offset:6144
    s_mov_b64 s[60:61], -1
    s_waitcnt vmcnt(4)
    v_mfma_f32_16x16x32_bf16 v[28:31], v[120:123], v[72:75], 0
    s_add_u32 s35, s26, 24576
    v_mfma_f32_16x16x32_bf16 v[32:35], v[124:127], v[72:75], 0
    v_mfma_f32_16x16x32_bf16 v[36:39], v[128:131], v[72:75], 0
    buffer_load_dwordx4 v[96:99], v14, s[52:55], s35 offen sc1
    v_mfma_f32_16x16x32_bf16 v[40:43], v[132:135], v[72:75], 0
    v_mfma_f32_16x16x32_bf16 v[44:47], v[120:123], v[76:79], 0
    v_mfma_f32_16x16x32_bf16 v[48:51], v[124:127], v[76:79], 0
    buffer_load_dwordx4 v[100:103], v68, s[52:55], s35 offen sc1
    v_mfma_f32_16x16x32_bf16 v[52:55], v[128:131], v[76:79], 0
    v_mfma_f32_16x16x32_bf16 v[56:59], v[132:135], v[76:79], 0
    s_branch L_p2_main
L_comp:
    s_setprio 3
    s_lshr_b32 s36, s23, 1
    s_and_b32 s37, s23, 1
    s_lshl_b32 s33, s21, 1
    s_add_u32 s33, s33, s36
    s_lshl_b32 s38, s22, 1
    s_add_u32 s38, s38, s37
    s_lshl_b32 s82, s21, 4
    s_add_u32 s82, s82, s22
    s_lshl_b32 s82, s82, 7
    s_add_u32 s82, s82, 8388608
    s_cmp_eq_u32 s20, 4
    s_cselect_b32 s82, s82, 0x40000000
    s_waitcnt lgkmcnt(0)
    s_setprio 1
    s_mov_b32 s52, s16
    s_mov_b32 s53, s17
    s_mov_b32 s54, 0xa00000
    s_mov_b32 s55, 0x20000
    s_mov_b32 s88, s78
    s_mov_b32 s89, s79
    s_mov_b32 s90, 0x100
    s_mov_b32 s91, 0x20000
    s_lshl_b32 s35, s2, 3
    s_add_u32 s35, s35, s20
    s_cmp_eq_u32 s35, 260
    s_cbranch_scc1 L_newtag
L_tagdone:
    s_mul_i32 s33, s33, 88064
    s_mul_i32 s35, s38, 3072
    s_add_u32 s33, s33, s35
    s_add_u32 s33, s33, 4096
    s_add_u32 s43, s33, 2818048
    v_and_b32 v48, 15, v1
    v_bfe_u32 v49, v1, 1, 3
    v_xor_b32 v49, v49, v6
    v_lshlrev_b32 v49, 4, v49
    v_lshl_add_u32 v49, v48, 7, v49
    s_lshl_b32 s35, s36, 6
    v_xor_b32 v49, s35, v49
    v_mov_b32 v50, v6
    s_lshl_b32 s35, s36, 13
    s_add_u32 s35, s35, 24576
    v_add_u32 v2, s35, v49
    v_xor_b32 v3, 64, v2
    v_add_u32 v4, 81920, v2
    v_add_u32 v5, 81920, v3
    v_bfe_u32 v49, v1, 2, 2
    v_lshl_add_u32 v49, v50, 3, v49
    v_mul_u32_u24 v49, 192, v49
    v_and_b32 v51, 3, v1
    v_lshl_add_u32 v49, v51, 3, v49
    v_and_b32 v51, 1, v50
    s_mul_i32 s38, s37, 3
    s_mul_i32 s39, s36, 6144
    s_sub_u32 s42, 6144, s39
    s_add_u32 s35, s38, 0
    v_xor_b32 v19, s35, v51
    v_lshl_add_u32 v19, v19, 5, v49
    v_add_u32 v6, s39, v19
    v_add_u32 v9, s42, v19
    s_add_u32 s35, s38, 1
    v_xor_b32 v19, s35, v51
    v_lshl_add_u32 v19, v19, 5, v49
    v_add_u32 v7, s39, v19
    v_add_u32 v10, s42, v19
    s_add_u32 s35, s38, 2
    v_xor_b32 v19, s35, v51
    v_lshl_add_u32 v19, v19, 5, v49
    v_add_u32 v8, s39, v19
    v_add_u32 v11, s42, v19
    v_add_u32 v12, 81920, v6
    v_add_u32 v13, 81920, v7
    v_add_u32 v14, 81920, v8
    v_add_u32 v15, 81920, v9
    v_add_u32 v16, 81920, v10
    v_add_u32 v17, 81920, v11
    v_mov_b32 v19, 0x3f803f80
    s_lshl_b32 s35, s36, 10
    v_lshl_add_u32 v18, v48, 4, s35
    v_cmp_eq_u32 vcc, 0, v48
    s_nop 1
    v_cndmask_b32 v24, 0, v19, vcc
    v_cndmask_b32 v25, 0, v19, vcc
    v_cndmask_b32 v26, 0, v19, vcc
    v_cndmask_b32 v27, 0, v19, vcc
    v_cmp_eq_u32 vcc, 4, v48
    s_nop 1
    v_cndmask_b32 v28, 0, v19, vcc
    v_cndmask_b32 v29, 0, v19, vcc
    v_cndmask_b32 v30, 0, v19, vcc
    v_cndmask_b32 v31, 0, v19, vcc
    v_cmp_eq_u32 vcc, 8, v48
    s_nop 1
    v_cndmask_b32 v32, 0, v19, vcc
    v_cndmask_b32 v33, 0, v19, vcc
    v_cndmask_b32 v34, 0, v19, vcc
    v_cndmask_b32 v35, 0, v19, vcc
    v_cmp_eq_u32 vcc, 12, v48
    s_nop 1
    v_cndmask_b32 v36, 0, v19, vcc
    v_cndmask_b32 v37, 0, v19, vcc
    v_cndmask_b32 v38, 0, v19, vcc
    v_cndmask_b32 v39, 0, v19, vcc
    v_cmp_eq_u32 vcc, 1, v48
    s_nop 1
    v_cndmask_b32 v40, 0, v19, vcc
    v_cndmask_b32 v41, 0, v19, vcc
    v_cndmask_b32 v42, 0, v19, vcc
    v_cndmask_b32 v43, 0, v19, vcc
    v_cmp_eq_u32 vcc, 5, v48
    s_nop 1
    v_cndmask_b32 v44, 0, v19, vcc
    v_cndmask_b32 v45, 0, v19, vcc
    v_cndmask_b32 v46, 0, v19, vcc
    v_cndmask_b32 v47, 0, v19, vcc
    s_lshl_b32 s35, s37, 10
    s_add_u32 s35, s35, 2048
    v_lshl_add_u32 v19, v50, 4, s35
    s_lshl_b32 s39, s36, 9
    s_add_u32 s35, s35, s39
    v_lshl_add_u32 v51, v1, 2, s35
    v_lshlrev_b32 v48, 4, v1
    s_cmp_ge_u32 s81, 4
    s_mov_b32 s64, 0x3a000000
    s_cselect_b32 s64, 0xba000000, s64
    s_lshr_b32 s35, s23, 1
    s_lshl_b32 s35, s35, 5
    s_add_u32 s35, s35, s80
    v_and_b32 v56, 15, v1
    v_lshl_add_u32 v56, v56, 6, s35
    v_cvt_f32_u32 v56, v56
    v_mul_f32 v56, s64, v56
    s_and_b32 s35, s23, 1
    s_lshl_b32 s35, s35, 5
    v_lshrrev_b32 v57, 4, v1
    v_lshl_add_u32 v57, v57, 2, s35
    v_cvt_f32_u32 v57, v57
    v_mul_f32 v57, v57, v56
    v_fmamk_f32 v58, v56, 0x00000000, v57
    v_fmamk_f32 v59, v56, 0x3f800000, v57
    v_fract_f32 v58, v58
    v_fract_f32 v59, v59
    v_cos_f32 v60, v58
    v_sin_f32 v58, v58
    v_cos_f32 v61, v59
    v_sin_f32 v59, v59
    v_cvt_pk_bf16_f32 v64, v60, v58
    v_cvt_pk_bf16_f32 v65, v61, v59
    v_fmamk_f32 v58, v56, 0x40000000, v57
    v_fmamk_f32 v59, v56, 0x40400000, v57
    v_fract_f32 v58, v58
    v_fract_f32 v59, v59
    v_cos_f32 v60, v58
    v_sin_f32 v58, v58
    v_cos_f32 v61, v59
    v_sin_f32 v59, v59
    v_cvt_pk_bf16_f32 v66, v60, v58
    v_cvt_pk_bf16_f32 v67, v61, v59
    v_fmamk_f32 v58, v56, 0x41800000, v57
    v_fmamk_f32 v59, v56, 0x41880000, v57
    v_fract_f32 v58, v58
    v_fract_f32 v59, v59
    v_cos_f32 v60, v58
    v_sin_f32 v58, v58
    v_cos_f32 v61, v59
    v_sin_f32 v59, v59
    v_cvt_pk_bf16_f32 v68, v60, v58
    v_cvt_pk_bf16_f32 v69, v61, v59
    v_fmamk_f32 v58, v56, 0x41900000, v57
    v_fmamk_f32 v59, v56, 0x41980000, v57
    v_fract_f32 v58, v58
    v_fract_f32 v59, v59
    v_cos_f32 v60, v58
    v_sin_f32 v58, v58
    v_cos_f32 v61, v59
    v_sin_f32 v59, v59
    v_cvt_pk_bf16_f32 v70, v60, v58
    v_cvt_pk_bf16_f32 v71, v61, v59
    s_lshl_b32 s35, s23, 11
    s_add_u32 s35, s35, 122880
    v_lshl_add_u32 v56, v1, 4, s35
    ds_write_b128 v56, v[64:67]
    ds_write_b128 v56, v[68:71] offset:1024
    v_mov_b32 v52, 122876
    s_waitcnt lgkmcnt(0)
    s_barrier
    ds_read_b64_tr_b16 v[72:73], v6
    ds_read_b64_tr_b16 v[74:75], v6 offset:768
    ds_read_b128 v[56:59], v2
    ds_read_b128 v[60:63], v2 offset:2048
    ds_read_b128 v[64:67], v2 offset:4096
    ds_read_b128 v[68:71], v2 offset:6144
    ds_read_b64_tr_b16 v[76:77], v6 offset:12288
    ds_read_b64_tr_b16 v[78:79], v6 offset:13056
    ds_read_b64_tr_b16 v[80:81], v7
    ds_read_b64_tr_b16 v[82:83], v7 offset:768
    ds_read_b64_tr_b16 v[84:85], v7 offset:12288
    ds_read_b64_tr_b16 v[86:87], v7 offset:13056
    ds_read_b64_tr_b16 v[88:89], v8
    ds_read_b64_tr_b16 v[90:91], v8 offset:768
    ds_read_b64_tr_b16 v[92:93], v8 offset:12288
    ds_read_b64_tr_b16 v[94:95], v8 offset:13056
    s_waitcnt lgkmcnt(0)
    .p2align 3
    v_mfma_f32_16x16x32_bf16 v[20:23], v[24:27], v[72:75], 0
    ds_read_b64_tr_b16 v[112:113], v9
    v_mfma_f32_16x16x32_bf16 v[20:23], v[28:31], v[76:79], v[20:23]
    ds_read_b64_tr_b16 v[114:115], v9 offset:768
    v_mfma_f32_16x16x32_bf16 v[20:23], v[32:35], v[80:83], v[20:23]
    ds_read_b128 v[96:99], v3
    v_mfma_f32_16x16x32_bf16 v[20:23], v[36:39], v[84:87], v[20:23]
    ds_read_b128 v[100:103], v3 offset:2048
    v_mfma_f32_16x16x32_bf16 v[20:23], v[40:43], v[88:91], v[20:23]
    v_mfma_f32_16x16x32_bf16 v[20:23], v[44:47], v[92:95], v[20:23]
    ds_read_b128 v[104:107], v3 offset:4096
    v_mfma_f32_16x16x32_bf16 v[136:139], v[72:75], v[56:59], 0
    ds_read_b128 v[108:111], v3 offset:6144
    v_mfma_f32_16x16x32_bf16 v[160:163], v[72:75], v[60:63], 0
    ds_read_b64_tr_b16 v[116:117], v9 offset:12288
    v_mfma_f32_16x16x32_bf16 v[184:187], v[72:75], v[64:67], 0
    ds_read_b64_tr_b16 v[118:119], v9 offset:13056
    v_mfma_f32_16x16x32_bf16 v[208:211], v[72:75], v[68:71], 0
    v_mfma_f32_16x16x32_bf16 v[140:143], v[76:79], v[56:59], 0
    ds_read_b64_tr_b16 v[120:121], v10
    v_mfma_f32_16x16x32_bf16 v[164:167], v[76:79], v[60:63], 0
    ds_read_b64_tr_b16 v[122:123], v10 offset:768
    v_mfma_f32_16x16x32_bf16 v[188:191], v[76:79], v[64:67], 0
    ds_read_b64_tr_b16 v[124:125], v10 offset:12288
    v_mfma_f32_16x16x32_bf16 v[212:215], v[76:79], v[68:71], 0
    ds_read_b64_tr_b16 v[126:127], v10 offset:13056
    v_mfma_f32_16x16x32_bf16 v[144:147], v[80:83], v[56:59], 0
    v_mfma_f32_16x16x32_bf16 v[168:171], v[80:83], v[60:63], 0
    ds_read_b64_tr_b16 v[128:129], v11
    v_mfma_f32_16x16x32_bf16 v[192:195], v[80:83], v[64:67], 0
    ds_read_b64_tr_b16 v[130:131], v11 offset:768
    v_mfma_f32_16x16x32_bf16 v[216:219], v[80:83], v[68:71], 0
    ds_read_b64_tr_b16 v[132:133], v11 offset:12288
    v_mfma_f32_16x16x32_bf16 v[148:151], v[84:87], v[56:59], 0
    ds_read_b64_tr_b16 v[134:135], v11 offset:13056
    v_mfma_f32_16x16x32_bf16 v[172:175], v[84:87], v[60:63], 0
    v_mfma_f32_16x16x32_bf16 v[196:199], v[84:87], v[64:67], 0
    v_mfma_f32_16x16x32_bf16 v[220:223], v[84:87], v[68:71], 0
    v_mfma_f32_16x16x32_bf16 v[152:155], v[88:91], v[56:59], 0
    v_mfma_f32_16x16x32_bf16 v[176:179], v[88:91], v[60:63], 0
    v_mfma_f32_16x16x32_bf16 v[200:203], v[88:91], v[64:67], 0
    v_mfma_f32_16x16x32_bf16 v[224:227], v[88:91], v[68:71], 0
    v_mfma_f32_16x16x32_bf16 v[156:159], v[92:95], v[56:59], 0
    v_mfma_f32_16x16x32_bf16 v[180:183], v[92:95], v[60:63], 0
    v_mfma_f32_16x16x32_bf16 v[204:207], v[92:95], v[64:67], 0
    v_mfma_f32_16x16x32_bf16 v[228:231], v[92:95], v[68:71], 0
    s_waitcnt lgkmcnt(0)
    s_barrier
    v_mfma_f32_16x16x32_bf16 v[136:139], v[112:115], v[96:99], v[136:139]
    ds_read_b64_tr_b16 v[72:73], v6 offset:40960
    v_mfma_f32_16x16x32_bf16 v[160:163], v[112:115], v[100:103], v[160:163]
    ds_read_b64_tr_b16 v[74:75], v6 offset:41728
    v_mfma_f32_16x16x32_bf16 v[184:187], v[112:115], v[104:107], v[184:187]
    ds_read_b128 v[56:59], v2 offset:40960
    v_mfma_f32_16x16x32_bf16 v[208:211], v[112:115], v[108:111], v[208:211]
    ds_read_b128 v[60:63], v2 offset:43008
    v_mfma_f32_16x16x32_bf16 v[140:143], v[116:119], v[96:99], v[140:143]
    ds_read_b128 v[64:67], v2 offset:45056
    v_mfma_f32_16x16x32_bf16 v[164:167], v[116:119], v[100:103], v[164:167]
    ds_read_b128 v[68:71], v2 offset:47104
    v_mfma_f32_16x16x32_bf16 v[188:191], v[116:119], v[104:107], v[188:191]
    ds_read_b64_tr_b16 v[76:77], v6 offset:53248
    v_mfma_f32_16x16x32_bf16 v[212:215], v[116:119], v[108:111], v[212:215]
    ds_read_b64_tr_b16 v[78:79], v6 offset:54016
    v_mfma_f32_16x16x32_bf16 v[144:147], v[120:123], v[96:99], v[144:147]
    ds_read_b64_tr_b16 v[80:81], v7 offset:40960
    v_mfma_f32_16x16x32_bf16 v[168:171], v[120:123], v[100:103], v[168:171]
    ds_read_b64_tr_b16 v[82:83], v7 offset:41728
    v_mfma_f32_16x16x32_bf16 v[192:195], v[120:123], v[104:107], v[192:195]
    ds_read_b64_tr_b16 v[84:85], v7 offset:53248
    v_mfma_f32_16x16x32_bf16 v[216:219], v[120:123], v[108:111], v[216:219]
    ds_read_b64_tr_b16 v[86:87], v7 offset:54016
    v_mfma_f32_16x16x32_bf16 v[148:151], v[124:127], v[96:99], v[148:151]
    ds_read_b64_tr_b16 v[88:89], v8 offset:40960
    v_mfma_f32_16x16x32_bf16 v[172:175], v[124:127], v[100:103], v[172:175]
    ds_read_b64_tr_b16 v[90:91], v8 offset:41728
    v_mfma_f32_16x16x32_bf16 v[196:199], v[124:127], v[104:107], v[196:199]
    ds_read_b64_tr_b16 v[92:93], v8 offset:53248
    v_mfma_f32_16x16x32_bf16 v[220:223], v[124:127], v[108:111], v[220:223]
    ds_read_b64_tr_b16 v[94:95], v8 offset:54016
    v_mfma_f32_16x16x32_bf16 v[152:155], v[128:131], v[96:99], v[152:155]
    v_mfma_f32_16x16x32_bf16 v[176:179], v[128:131], v[100:103], v[176:179]
    v_mfma_f32_16x16x32_bf16 v[200:203], v[128:131], v[104:107], v[200:203]
    v_mfma_f32_16x16x32_bf16 v[224:227], v[128:131], v[108:111], v[224:227]
    v_mfma_f32_16x16x32_bf16 v[156:159], v[132:135], v[96:99], v[156:159]
    v_mfma_f32_16x16x32_bf16 v[180:183], v[132:135], v[100:103], v[180:183]
    v_mfma_f32_16x16x32_bf16 v[204:207], v[132:135], v[104:107], v[204:207]
    v_mfma_f32_16x16x32_bf16 v[228:231], v[132:135], v[108:111], v[228:231]
    s_waitcnt lgkmcnt(0)
    .p2align 3
    v_mfma_f32_16x16x32_bf16 v[20:23], v[24:27], v[72:75], v[20:23]
    ds_read_b64_tr_b16 v[112:113], v9 offset:40960
    v_mfma_f32_16x16x32_bf16 v[20:23], v[28:31], v[76:79], v[20:23]
    ds_read_b64_tr_b16 v[114:115], v9 offset:41728
    v_mfma_f32_16x16x32_bf16 v[20:23], v[32:35], v[80:83], v[20:23]
    ds_read_b128 v[96:99], v3 offset:40960
    v_mfma_f32_16x16x32_bf16 v[20:23], v[36:39], v[84:87], v[20:23]
    ds_read_b128 v[100:103], v3 offset:43008
    v_mfma_f32_16x16x32_bf16 v[20:23], v[40:43], v[88:91], v[20:23]
    v_mfma_f32_16x16x32_bf16 v[20:23], v[44:47], v[92:95], v[20:23]
    ds_read_b128 v[104:107], v3 offset:45056
    v_mfma_f32_16x16x32_bf16 v[136:139], v[72:75], v[56:59], v[136:139]
    ds_read_b128 v[108:111], v3 offset:47104
    v_mfma_f32_16x16x32_bf16 v[160:163], v[72:75], v[60:63], v[160:163]
    ds_read_b64_tr_b16 v[116:117], v9 offset:53248
    v_mfma_f32_16x16x32_bf16 v[184:187], v[72:75], v[64:67], v[184:187]
    ds_read_b64_tr_b16 v[118:119], v9 offset:54016
    v_mfma_f32_16x16x32_bf16 v[208:211], v[72:75], v[68:71], v[208:211]
    v_mfma_f32_16x16x32_bf16 v[140:143], v[76:79], v[56:59], v[140:143]
    ds_read_b64_tr_b16 v[120:121], v10 offset:40960
    v_mfma_f32_16x16x32_bf16 v[164:167], v[76:79], v[60:63], v[164:167]
    ds_read_b64_tr_b16 v[122:123], v10 offset:41728
    v_mfma_f32_16x16x32_bf16 v[188:191], v[76:79], v[64:67], v[188:191]
    ds_read_b64_tr_b16 v[124:125], v10 offset:53248
    v_mfma_f32_16x16x32_bf16 v[212:215], v[76:79], v[68:71], v[212:215]
    ds_read_b64_tr_b16 v[126:127], v10 offset:54016
    v_mfma_f32_16x16x32_bf16 v[144:147], v[80:83], v[56:59], v[144:147]
    v_mfma_f32_16x16x32_bf16 v[168:171], v[80:83], v[60:63], v[168:171]
    ds_read_b64_tr_b16 v[128:129], v11 offset:40960
    v_mfma_f32_16x16x32_bf16 v[192:195], v[80:83], v[64:67], v[192:195]
    ds_read_b64_tr_b16 v[130:131], v11 offset:41728
    v_mfma_f32_16x16x32_bf16 v[216:219], v[80:83], v[68:71], v[216:219]
    ds_read_b64_tr_b16 v[132:133], v11 offset:53248
    v_mfma_f32_16x16x32_bf16 v[148:151], v[84:87], v[56:59], v[148:151]
    ds_read_b64_tr_b16 v[134:135], v11 offset:54016
    v_mfma_f32_16x16x32_bf16 v[172:175], v[84:87], v[60:63], v[172:175]
    v_mfma_f32_16x16x32_bf16 v[196:199], v[84:87], v[64:67], v[196:199]
    v_mfma_f32_16x16x32_bf16 v[220:223], v[84:87], v[68:71], v[220:223]
    v_mfma_f32_16x16x32_bf16 v[152:155], v[88:91], v[56:59], v[152:155]
    v_mfma_f32_16x16x32_bf16 v[176:179], v[88:91], v[60:63], v[176:179]
    v_mfma_f32_16x16x32_bf16 v[200:203], v[88:91], v[64:67], v[200:203]
    v_mfma_f32_16x16x32_bf16 v[224:227], v[88:91], v[68:71], v[224:227]
    v_mfma_f32_16x16x32_bf16 v[156:159], v[92:95], v[56:59], v[156:159]
    v_mfma_f32_16x16x32_bf16 v[180:183], v[92:95], v[60:63], v[180:183]
    v_mfma_f32_16x16x32_bf16 v[204:207], v[92:95], v[64:67], v[204:207]
    v_mfma_f32_16x16x32_bf16 v[228:231], v[92:95], v[68:71], v[228:231]
    s_waitcnt lgkmcnt(0)
    s_barrier
    v_mfma_f32_16x16x32_bf16 v[136:139], v[112:115], v[96:99], v[136:139]
    ds_read_b64_tr_b16 v[72:73], v12
    v_mfma_f32_16x16x32_bf16 v[160:163], v[112:115], v[100:103], v[160:163]
    ds_read_b64_tr_b16 v[74:75], v12 offset:768
    v_mfma_f32_16x16x32_bf16 v[184:187], v[112:115], v[104:107], v[184:187]
    ds_read_b128 v[56:59], v4
    v_mfma_f32_16x16x32_bf16 v[208:211], v[112:115], v[108:111], v[208:211]
    ds_read_b128 v[60:63], v4 offset:2048
    v_mfma_f32_16x16x32_bf16 v[140:143], v[116:119], v[96:99], v[140:143]
    ds_read_b128 v[64:67], v4 offset:4096
    v_mfma_f32_16x16x32_bf16 v[164:167], v[116:119], v[100:103], v[164:167]
    ds_read_b128 v[68:71], v4 offset:6144
    v_mfma_f32_16x16x32_bf16 v[188:191], v[116:119], v[104:107], v[188:191]
    ds_read_b64_tr_b16 v[76:77], v12 offset:12288
    v_mfma_f32_16x16x32_bf16 v[212:215], v[116:119], v[108:111], v[212:215]
    ds_read_b64_tr_b16 v[78:79], v12 offset:13056
    v_mfma_f32_16x16x32_bf16 v[144:147], v[120:123], v[96:99], v[144:147]
    ds_read_b64_tr_b16 v[80:81], v13
    v_mfma_f32_16x16x32_bf16 v[168:171], v[120:123], v[100:103], v[168:171]
    ds_read_b64_tr_b16 v[82:83], v13 offset:768
    v_mfma_f32_16x16x32_bf16 v[192:195], v[120:123], v[104:107], v[192:195]
    ds_read_b64_tr_b16 v[84:85], v13 offset:12288
    v_mfma_f32_16x16x32_bf16 v[216:219], v[120:123], v[108:111], v[216:219]
    ds_read_b64_tr_b16 v[86:87], v13 offset:13056
    v_mfma_f32_16x16x32_bf16 v[148:151], v[124:127], v[96:99], v[148:151]
    ds_read_b64_tr_b16 v[88:89], v14
    v_mfma_f32_16x16x32_bf16 v[172:175], v[124:127], v[100:103], v[172:175]
    ds_read_b64_tr_b16 v[90:91], v14 offset:768
    v_mfma_f32_16x16x32_bf16 v[196:199], v[124:127], v[104:107], v[196:199]
    ds_read_b64_tr_b16 v[92:93], v14 offset:12288
    v_mfma_f32_16x16x32_bf16 v[220:223], v[124:127], v[108:111], v[220:223]
    ds_read_b64_tr_b16 v[94:95], v14 offset:13056
    v_mfma_f32_16x16x32_bf16 v[152:155], v[128:131], v[96:99], v[152:155]
    v_mfma_f32_16x16x32_bf16 v[176:179], v[128:131], v[100:103], v[176:179]
    v_mfma_f32_16x16x32_bf16 v[200:203], v[128:131], v[104:107], v[200:203]
    v_mfma_f32_16x16x32_bf16 v[224:227], v[128:131], v[108:111], v[224:227]
    v_mfma_f32_16x16x32_bf16 v[156:159], v[132:135], v[96:99], v[156:159]
    v_mfma_f32_16x16x32_bf16 v[180:183], v[132:135], v[100:103], v[180:183]
    v_mfma_f32_16x16x32_bf16 v[204:207], v[132:135], v[104:107], v[204:207]
    v_mfma_f32_16x16x32_bf16 v[228:231], v[132:135], v[108:111], v[228:231]
    s_waitcnt lgkmcnt(0)
    .p2align 3
    v_mfma_f32_16x16x32_bf16 v[20:23], v[24:27], v[72:75], v[20:23]
    ds_read_b64_tr_b16 v[112:113], v15
    v_mfma_f32_16x16x32_bf16 v[20:23], v[28:31], v[76:79], v[20:23]
    ds_read_b64_tr_b16 v[114:115], v15 offset:768
    v_mfma_f32_16x16x32_bf16 v[20:23], v[32:35], v[80:83], v[20:23]
    ds_read_b128 v[96:99], v5
    v_mfma_f32_16x16x32_bf16 v[20:23], v[36:39], v[84:87], v[20:23]
    ds_read_b128 v[100:103], v5 offset:2048
    v_mfma_f32_16x16x32_bf16 v[20:23], v[40:43], v[88:91], v[20:23]
    v_mfma_f32_16x16x32_bf16 v[20:23], v[44:47], v[92:95], v[20:23]
    ds_read_b128 v[104:107], v5 offset:4096
    v_mfma_f32_16x16x32_bf16 v[136:139], v[72:75], v[56:59], v[136:139]
    ds_read_b128 v[108:111], v5 offset:6144
    v_mfma_f32_16x16x32_bf16 v[160:163], v[72:75], v[60:63], v[160:163]
    ds_read_b64_tr_b16 v[116:117], v15 offset:12288
    v_mfma_f32_16x16x32_bf16 v[184:187], v[72:75], v[64:67], v[184:187]
    ds_read_b64_tr_b16 v[118:119], v15 offset:13056
    v_mfma_f32_16x16x32_bf16 v[208:211], v[72:75], v[68:71], v[208:211]
    v_mfma_f32_16x16x32_bf16 v[140:143], v[76:79], v[56:59], v[140:143]
    ds_read_b64_tr_b16 v[120:121], v16
    v_mfma_f32_16x16x32_bf16 v[164:167], v[76:79], v[60:63], v[164:167]
    ds_read_b64_tr_b16 v[122:123], v16 offset:768
    v_mfma_f32_16x16x32_bf16 v[188:191], v[76:79], v[64:67], v[188:191]
    ds_read_b64_tr_b16 v[124:125], v16 offset:12288
    v_mfma_f32_16x16x32_bf16 v[212:215], v[76:79], v[68:71], v[212:215]
    ds_read_b64_tr_b16 v[126:127], v16 offset:13056
    v_mfma_f32_16x16x32_bf16 v[144:147], v[80:83], v[56:59], v[144:147]
    v_mfma_f32_16x16x32_bf16 v[168:171], v[80:83], v[60:63], v[168:171]
    ds_read_b64_tr_b16 v[128:129], v17
    v_mfma_f32_16x16x32_bf16 v[192:195], v[80:83], v[64:67], v[192:195]
    ds_read_b64_tr_b16 v[130:131], v17 offset:768
    v_mfma_f32_16x16x32_bf16 v[216:219], v[80:83], v[68:71], v[216:219]
    ds_read_b64_tr_b16 v[132:133], v17 offset:12288
    v_mfma_f32_16x16x32_bf16 v[148:151], v[84:87], v[56:59], v[148:151]
    ds_read_b64_tr_b16 v[134:135], v17 offset:13056
    v_mfma_f32_16x16x32_bf16 v[172:175], v[84:87], v[60:63], v[172:175]
    v_mfma_f32_16x16x32_bf16 v[196:199], v[84:87], v[64:67], v[196:199]
    v_mfma_f32_16x16x32_bf16 v[220:223], v[84:87], v[68:71], v[220:223]
    v_mfma_f32_16x16x32_bf16 v[152:155], v[88:91], v[56:59], v[152:155]
    v_mfma_f32_16x16x32_bf16 v[176:179], v[88:91], v[60:63], v[176:179]
    v_mfma_f32_16x16x32_bf16 v[200:203], v[88:91], v[64:67], v[200:203]
    v_mfma_f32_16x16x32_bf16 v[224:227], v[88:91], v[68:71], v[224:227]
    v_mfma_f32_16x16x32_bf16 v[156:159], v[92:95], v[56:59], v[156:159]
    v_mfma_f32_16x16x32_bf16 v[180:183], v[92:95], v[60:63], v[180:183]
    v_mfma_f32_16x16x32_bf16 v[204:207], v[92:95], v[64:67], v[204:207]
    v_mfma_f32_16x16x32_bf16 v[228:231], v[92:95], v[68:71], v[228:231]
    s_waitcnt lgkmcnt(0)
    s_barrier
    v_mfma_f32_16x16x32_bf16 v[136:139], v[112:115], v[96:99], v[136:139]
    ds_read_b64_tr_b16 v[72:73], v12 offset:40960
    v_mfma_f32_16x16x32_bf16 v[160:163], v[112:115], v[100:103], v[160:163]
    ds_read_b64_tr_b16 v[74:75], v12 offset:41728
    v_mfma_f32_16x16x32_bf16 v[184:187], v[112:115], v[104:107], v[184:187]
    ds_read_b128 v[56:59], v4 offset:40960
    v_mfma_f32_16x16x32_bf16 v[208:211], v[112:115], v[108:111], v[208:211]
    ds_read_b128 v[60:63], v4 offset:43008
    v_mfma_f32_16x16x32_bf16 v[140:143], v[116:119], v[96:99], v[140:143]
    ds_read_b128 v[64:67], v4 offset:45056
    v_mfma_f32_16x16x32_bf16 v[164:167], v[116:119], v[100:103], v[164:167]
    ds_read_b128 v[68:71], v4 offset:47104
    v_mfma_f32_16x16x32_bf16 v[188:191], v[116:119], v[104:107], v[188:191]
    ds_read_b64_tr_b16 v[76:77], v12 offset:53248
    v_mfma_f32_16x16x32_bf16 v[212:215], v[116:119], v[108:111], v[212:215]
    ds_read_b64_tr_b16 v[78:79], v12 offset:54016
    v_mfma_f32_16x16x32_bf16 v[144:147], v[120:123], v[96:99], v[144:147]
    ds_read_b64_tr_b16 v[80:81], v13 offset:40960
    v_mfma_f32_16x16x32_bf16 v[168:171], v[120:123], v[100:103], v[168:171]
    ds_read_b64_tr_b16 v[82:83], v13 offset:41728
    v_mfma_f32_16x16x32_bf16 v[192:195], v[120:123], v[104:107], v[192:195]
    ds_read_b64_tr_b16 v[84:85], v13 offset:53248
    v_mfma_f32_16x16x32_bf16 v[216:219], v[120:123], v[108:111], v[216:219]
    ds_read_b64_tr_b16 v[86:87], v13 offset:54016
    v_mfma_f32_16x16x32_bf16 v[148:151], v[124:127], v[96:99], v[148:151]
    ds_read_b64_tr_b16 v[88:89], v14 offset:40960
    v_mfma_f32_16x16x32_bf16 v[172:175], v[124:127], v[100:103], v[172:175]
    ds_read_b64_tr_b16 v[90:91], v14 offset:41728
    v_mfma_f32_16x16x32_bf16 v[196:199], v[124:127], v[104:107], v[196:199]
    ds_read_b64_tr_b16 v[92:93], v14 offset:53248
    v_mfma_f32_16x16x32_bf16 v[220:223], v[124:127], v[108:111], v[220:223]
    ds_read_b64_tr_b16 v[94:95], v14 offset:54016
    v_mfma_f32_16x16x32_bf16 v[152:155], v[128:131], v[96:99], v[152:155]
    v_mfma_f32_16x16x32_bf16 v[176:179], v[128:131], v[100:103], v[176:179]
    v_mfma_f32_16x16x32_bf16 v[200:203], v[128:131], v[104:107], v[200:203]
    v_mfma_f32_16x16x32_bf16 v[224:227], v[128:131], v[108:111], v[224:227]
    v_mfma_f32_16x16x32_bf16 v[156:159], v[132:135], v[96:99], v[156:159]
    v_mfma_f32_16x16x32_bf16 v[180:183], v[132:135], v[100:103], v[180:183]
    v_mfma_f32_16x16x32_bf16 v[204:207], v[132:135], v[104:107], v[204:207]
    v_mfma_f32_16x16x32_bf16 v[228:231], v[132:135], v[108:111], v[228:231]
    s_waitcnt lgkmcnt(0)
    .p2align 3
    v_mfma_f32_16x16x32_bf16 v[20:23], v[24:27], v[72:75], v[20:23]
    ds_read_b64_tr_b16 v[112:113], v15 offset:40960
    v_mfma_f32_16x16x32_bf16 v[20:23], v[28:31], v[76:79], v[20:23]
    ds_read_b64_tr_b16 v[114:115], v15 offset:41728
    v_mfma_f32_16x16x32_bf16 v[20:23], v[32:35], v[80:83], v[20:23]
    ds_read_b128 v[96:99], v5 offset:40960
    v_mfma_f32_16x16x32_bf16 v[20:23], v[36:39], v[84:87], v[20:23]
    ds_read_b128 v[100:103], v5 offset:43008
    v_mfma_f32_16x16x32_bf16 v[20:23], v[40:43], v[88:91], v[20:23]
    v_mfma_f32_16x16x32_bf16 v[20:23], v[44:47], v[92:95], v[20:23]
    ds_read_b128 v[104:107], v5 offset:45056
    v_mfma_f32_16x16x32_bf16 v[136:139], v[72:75], v[56:59], v[136:139]
    ds_read_b128 v[108:111], v5 offset:47104
    v_mfma_f32_16x16x32_bf16 v[160:163], v[72:75], v[60:63], v[160:163]
    ds_read_b64_tr_b16 v[116:117], v15 offset:53248
    v_mfma_f32_16x16x32_bf16 v[184:187], v[72:75], v[64:67], v[184:187]
    ds_read_b64_tr_b16 v[118:119], v15 offset:54016
    v_mfma_f32_16x16x32_bf16 v[208:211], v[72:75], v[68:71], v[208:211]
    v_mfma_f32_16x16x32_bf16 v[140:143], v[76:79], v[56:59], v[140:143]
    ds_read_b64_tr_b16 v[120:121], v16 offset:40960
    v_mfma_f32_16x16x32_bf16 v[164:167], v[76:79], v[60:63], v[164:167]
    ds_read_b64_tr_b16 v[122:123], v16 offset:41728
    v_mfma_f32_16x16x32_bf16 v[188:191], v[76:79], v[64:67], v[188:191]
    ds_read_b64_tr_b16 v[124:125], v16 offset:53248
    v_mfma_f32_16x16x32_bf16 v[212:215], v[76:79], v[68:71], v[212:215]
    ds_read_b64_tr_b16 v[126:127], v16 offset:54016
    v_mfma_f32_16x16x32_bf16 v[144:147], v[80:83], v[56:59], v[144:147]
    v_mfma_f32_16x16x32_bf16 v[168:171], v[80:83], v[60:63], v[168:171]
    ds_read_b64_tr_b16 v[128:129], v17 offset:40960
    v_mfma_f32_16x16x32_bf16 v[192:195], v[80:83], v[64:67], v[192:195]
    ds_read_b64_tr_b16 v[130:131], v17 offset:41728
    v_mfma_f32_16x16x32_bf16 v[216:219], v[80:83], v[68:71], v[216:219]
    ds_read_b64_tr_b16 v[132:133], v17 offset:53248
    v_mfma_f32_16x16x32_bf16 v[148:151], v[84:87], v[56:59], v[148:151]
    ds_read_b64_tr_b16 v[134:135], v17 offset:54016
    v_mfma_f32_16x16x32_bf16 v[172:175], v[84:87], v[60:63], v[172:175]
    v_mfma_f32_16x16x32_bf16 v[196:199], v[84:87], v[64:67], v[196:199]
    v_mfma_f32_16x16x32_bf16 v[220:223], v[84:87], v[68:71], v[220:223]
    v_mfma_f32_16x16x32_bf16 v[152:155], v[88:91], v[56:59], v[152:155]
    v_mfma_f32_16x16x32_bf16 v[176:179], v[88:91], v[60:63], v[176:179]
    v_mfma_f32_16x16x32_bf16 v[200:203], v[88:91], v[64:67], v[200:203]
    v_mfma_f32_16x16x32_bf16 v[224:227], v[88:91], v[68:71], v[224:227]
    v_mfma_f32_16x16x32_bf16 v[156:159], v[92:95], v[56:59], v[156:159]
    v_mfma_f32_16x16x32_bf16 v[180:183], v[92:95], v[60:63], v[180:183]
    v_mfma_f32_16x16x32_bf16 v[204:207], v[92:95], v[64:67], v[204:207]
    v_mfma_f32_16x16x32_bf16 v[228:231], v[92:95], v[68:71], v[228:231]
    s_waitcnt lgkmcnt(0)
    s_barrier
    v_mfma_f32_16x16x32_bf16 v[136:139], v[112:115], v[96:99], v[136:139]
    ds_read_b64_tr_b16 v[72:73], v6
    v_mfma_f32_16x16x32_bf16 v[160:163], v[112:115], v[100:103], v[160:163]
    ds_read_b64_tr_b16 v[74:75], v6 offset:768
    v_mfma_f32_16x16x32_bf16 v[184:187], v[112:115], v[104:107], v[184:187]
    ds_read_b128 v[56:59], v2
    v_mfma_f32_16x16x32_bf16 v[208:211], v[112:115], v[108:111], v[208:211]
    ds_read_b128 v[60:63], v2 offset:2048
    v_mfma_f32_16x16x32_bf16 v[140:143], v[116:119], v[96:99], v[140:143]
    ds_read_b128 v[64:67], v2 offset:4096
    v_mfma_f32_16x16x32_bf16 v[164:167], v[116:119], v[100:103], v[164:167]
    ds_read_b128 v[68:71], v2 offset:6144
    v_mfma_f32_16x16x32_bf16 v[188:191], v[116:119], v[104:107], v[188:191]
    ds_read_b64_tr_b16 v[76:77], v6 offset:12288
    v_mfma_f32_16x16x32_bf16 v[212:215], v[116:119], v[108:111], v[212:215]
    ds_read_b64_tr_b16 v[78:79], v6 offset:13056
    v_mfma_f32_16x16x32_bf16 v[144:147], v[120:123], v[96:99], v[144:147]
    ds_read_b64_tr_b16 v[80:81], v7
    v_mfma_f32_16x16x32_bf16 v[168:171], v[120:123], v[100:103], v[168:171]
    ds_read_b64_tr_b16 v[82:83], v7 offset:768
    v_mfma_f32_16x16x32_bf16 v[192:195], v[120:123], v[104:107], v[192:195]
    ds_read_b64_tr_b16 v[84:85], v7 offset:12288
    v_mfma_f32_16x16x32_bf16 v[216:219], v[120:123], v[108:111], v[216:219]
    ds_read_b64_tr_b16 v[86:87], v7 offset:13056
    v_mfma_f32_16x16x32_bf16 v[148:151], v[124:127], v[96:99], v[148:151]
    ds_read_b64_tr_b16 v[88:89], v8
    v_mfma_f32_16x16x32_bf16 v[172:175], v[124:127], v[100:103], v[172:175]
    ds_read_b64_tr_b16 v[90:91], v8 offset:768
    v_mfma_f32_16x16x32_bf16 v[196:199], v[124:127], v[104:107], v[196:199]
    ds_read_b64_tr_b16 v[92:93], v8 offset:12288
    v_mfma_f32_16x16x32_bf16 v[220:223], v[124:127], v[108:111], v[220:223]
    ds_read_b64_tr_b16 v[94:95], v8 offset:13056
    v_mfma_f32_16x16x32_bf16 v[152:155], v[128:131], v[96:99], v[152:155]
    v_mfma_f32_16x16x32_bf16 v[176:179], v[128:131], v[100:103], v[176:179]
    v_mfma_f32_16x16x32_bf16 v[200:203], v[128:131], v[104:107], v[200:203]
    v_mfma_f32_16x16x32_bf16 v[224:227], v[128:131], v[108:111], v[224:227]
    v_mfma_f32_16x16x32_bf16 v[156:159], v[132:135], v[96:99], v[156:159]
    v_mfma_f32_16x16x32_bf16 v[180:183], v[132:135], v[100:103], v[180:183]
    v_mfma_f32_16x16x32_bf16 v[204:207], v[132:135], v[104:107], v[204:207]
    v_mfma_f32_16x16x32_bf16 v[228:231], v[132:135], v[108:111], v[228:231]
    s_waitcnt lgkmcnt(0)
    .p2align 3
    v_mfma_f32_16x16x32_bf16 v[20:23], v[24:27], v[72:75], v[20:23]
    ds_read_b64_tr_b16 v[112:113], v9
    v_mfma_f32_16x16x32_bf16 v[20:23], v[28:31], v[76:79], v[20:23]
    ds_read_b64_tr_b16 v[114:115], v9 offset:768
    v_mfma_f32_16x16x32_bf16 v[20:23], v[32:35], v[80:83], v[20:23]
    ds_read_b128 v[96:99], v3
    v_mfma_f32_16x16x32_bf16 v[20:23], v[36:39], v[84:87], v[20:23]
    ds_read_b128 v[100:103], v3 offset:2048
    v_mfma_f32_16x16x32_bf16 v[20:23], v[40:43], v[88:91], v[20:23]
    v_mfma_f32_16x16x32_bf16 v[20:23], v[44:47], v[92:95], v[20:23]
    ds_read_b128 v[104:107], v3 offset:4096
    v_mfma_f32_16x16x32_bf16 v[136:139], v[72:75], v[56:59], v[136:139]
    ds_read_b128 v[108:111], v3 offset:6144
    v_mfma_f32_16x16x32_bf16 v[160:163], v[72:75], v[60:63], v[160:163]
    ds_read_b64_tr_b16 v[116:117], v9 offset:12288
    v_mfma_f32_16x16x32_bf16 v[184:187], v[72:75], v[64:67], v[184:187]
    ds_read_b64_tr_b16 v[118:119], v9 offset:13056
    v_mfma_f32_16x16x32_bf16 v[208:211], v[72:75], v[68:71], v[208:211]
    v_mfma_f32_16x16x32_bf16 v[140:143], v[76:79], v[56:59], v[140:143]
    ds_read_b64_tr_b16 v[120:121], v10
    v_mfma_f32_16x16x32_bf16 v[164:167], v[76:79], v[60:63], v[164:167]
    ds_read_b64_tr_b16 v[122:123], v10 offset:768
    v_mfma_f32_16x16x32_bf16 v[188:191], v[76:79], v[64:67], v[188:191]
    ds_read_b64_tr_b16 v[124:125], v10 offset:12288
    v_mfma_f32_16x16x32_bf16 v[212:215], v[76:79], v[68:71], v[212:215]
    ds_read_b64_tr_b16 v[126:127], v10 offset:13056
    v_mfma_f32_16x16x32_bf16 v[144:147], v[80:83], v[56:59], v[144:147]
    v_mfma_f32_16x16x32_bf16 v[168:171], v[80:83], v[60:63], v[168:171]
    ds_read_b64_tr_b16 v[128:129], v11
    v_mfma_f32_16x16x32_bf16 v[192:195], v[80:83], v[64:67], v[192:195]
    ds_read_b64_tr_b16 v[130:131], v11 offset:768
    v_mfma_f32_16x16x32_bf16 v[216:219], v[80:83], v[68:71], v[216:219]
    ds_read_b64_tr_b16 v[132:133], v11 offset:12288
    v_mfma_f32_16x16x32_bf16 v[148:151], v[84:87], v[56:59], v[148:151]
    ds_read_b64_tr_b16 v[134:135], v11 offset:13056
    v_mfma_f32_16x16x32_bf16 v[172:175], v[84:87], v[60:63], v[172:175]
    v_mfma_f32_16x16x32_bf16 v[196:199], v[84:87], v[64:67], v[196:199]
    v_mfma_f32_16x16x32_bf16 v[220:223], v[84:87], v[68:71], v[220:223]
    v_mfma_f32_16x16x32_bf16 v[152:155], v[88:91], v[56:59], v[152:155]
    v_mfma_f32_16x16x32_bf16 v[176:179], v[88:91], v[60:63], v[176:179]
    v_mfma_f32_16x16x32_bf16 v[200:203], v[88:91], v[64:67], v[200:203]
    v_mfma_f32_16x16x32_bf16 v[224:227], v[88:91], v[68:71], v[224:227]
    v_mfma_f32_16x16x32_bf16 v[156:159], v[92:95], v[56:59], v[156:159]
    v_mfma_f32_16x16x32_bf16 v[180:183], v[92:95], v[60:63], v[180:183]
    v_mfma_f32_16x16x32_bf16 v[204:207], v[92:95], v[64:67], v[204:207]
    v_mfma_f32_16x16x32_bf16 v[228:231], v[92:95], v[68:71], v[228:231]
    s_waitcnt lgkmcnt(0)
    s_barrier
    v_mfma_f32_16x16x32_bf16 v[136:139], v[112:115], v[96:99], v[136:139]
    ds_read_b64_tr_b16 v[72:73], v6 offset:40960
    v_mfma_f32_16x16x32_bf16 v[160:163], v[112:115], v[100:103], v[160:163]
    ds_read_b64_tr_b16 v[74:75], v6 offset:41728
    v_mfma_f32_16x16x32_bf16 v[184:187], v[112:115], v[104:107], v[184:187]
    ds_read_b128 v[56:59], v2 offset:40960
    v_mfma_f32_16x16x32_bf16 v[208:211], v[112:115], v[108:111], v[208:211]
    ds_read_b128 v[60:63], v2 offset:43008
    v_mfma_f32_16x16x32_bf16 v[140:143], v[116:119], v[96:99], v[140:143]
    ds_read_b128 v[64:67], v2 offset:45056
    v_mfma_f32_16x16x32_bf16 v[164:167], v[116:119], v[100:103], v[164:167]
    ds_read_b128 v[68:71], v2 offset:47104
    v_mfma_f32_16x16x32_bf16 v[188:191], v[116:119], v[104:107], v[188:191]
    ds_read_b64_tr_b16 v[76:77], v6 offset:53248
    v_mfma_f32_16x16x32_bf16 v[212:215], v[116:119], v[108:111], v[212:215]
    ds_read_b64_tr_b16 v[78:79], v6 offset:54016
    v_mfma_f32_16x16x32_bf16 v[144:147], v[120:123], v[96:99], v[144:147]
    ds_read_b64_tr_b16 v[80:81], v7 offset:40960
    v_mfma_f32_16x16x32_bf16 v[168:171], v[120:123], v[100:103], v[168:171]
    ds_read_b64_tr_b16 v[82:83], v7 offset:41728
    v_mfma_f32_16x16x32_bf16 v[192:195], v[120:123], v[104:107], v[192:195]
    ds_read_b64_tr_b16 v[84:85], v7 offset:53248
    v_mfma_f32_16x16x32_bf16 v[216:219], v[120:123], v[108:111], v[216:219]
    ds_read_b64_tr_b16 v[86:87], v7 offset:54016
    v_mfma_f32_16x16x32_bf16 v[148:151], v[124:127], v[96:99], v[148:151]
    ds_read_b64_tr_b16 v[88:89], v8 offset:40960
    v_mfma_f32_16x16x32_bf16 v[172:175], v[124:127], v[100:103], v[172:175]
    ds_read_b64_tr_b16 v[90:91], v8 offset:41728
    v_mfma_f32_16x16x32_bf16 v[196:199], v[124:127], v[104:107], v[196:199]
    ds_read_b64_tr_b16 v[92:93], v8 offset:53248
    v_mfma_f32_16x16x32_bf16 v[220:223], v[124:127], v[108:111], v[220:223]
    ds_read_b64_tr_b16 v[94:95], v8 offset:54016
    v_mfma_f32_16x16x32_bf16 v[152:155], v[128:131], v[96:99], v[152:155]
    v_mfma_f32_16x16x32_bf16 v[176:179], v[128:131], v[100:103], v[176:179]
    v_mfma_f32_16x16x32_bf16 v[200:203], v[128:131], v[104:107], v[200:203]
    v_mfma_f32_16x16x32_bf16 v[224:227], v[128:131], v[108:111], v[224:227]
    v_mfma_f32_16x16x32_bf16 v[156:159], v[132:135], v[96:99], v[156:159]
    v_mfma_f32_16x16x32_bf16 v[180:183], v[132:135], v[100:103], v[180:183]
    v_mfma_f32_16x16x32_bf16 v[204:207], v[132:135], v[104:107], v[204:207]
    v_mfma_f32_16x16x32_bf16 v[228:231], v[132:135], v[108:111], v[228:231]
    s_waitcnt lgkmcnt(0)
    .p2align 3
    v_mfma_f32_16x16x32_bf16 v[20:23], v[24:27], v[72:75], v[20:23]
    ds_read_b64_tr_b16 v[112:113], v9 offset:40960
    v_mfma_f32_16x16x32_bf16 v[20:23], v[28:31], v[76:79], v[20:23]
    ds_read_b64_tr_b16 v[114:115], v9 offset:41728
    v_mfma_f32_16x16x32_bf16 v[20:23], v[32:35], v[80:83], v[20:23]
    ds_read_b128 v[96:99], v3 offset:40960
    v_mfma_f32_16x16x32_bf16 v[20:23], v[36:39], v[84:87], v[20:23]
    ds_read_b128 v[100:103], v3 offset:43008
    v_mfma_f32_16x16x32_bf16 v[20:23], v[40:43], v[88:91], v[20:23]
    v_mfma_f32_16x16x32_bf16 v[20:23], v[44:47], v[92:95], v[20:23]
    ds_read_b128 v[104:107], v3 offset:45056
    v_mfma_f32_16x16x32_bf16 v[136:139], v[72:75], v[56:59], v[136:139]
    ds_read_b128 v[108:111], v3 offset:47104
    v_mfma_f32_16x16x32_bf16 v[160:163], v[72:75], v[60:63], v[160:163]
    ds_read_b64_tr_b16 v[116:117], v9 offset:53248
    v_mfma_f32_16x16x32_bf16 v[184:187], v[72:75], v[64:67], v[184:187]
    ds_read_b64_tr_b16 v[118:119], v9 offset:54016
    v_mfma_f32_16x16x32_bf16 v[208:211], v[72:75], v[68:71], v[208:211]
    v_mfma_f32_16x16x32_bf16 v[140:143], v[76:79], v[56:59], v[140:143]
    ds_read_b64_tr_b16 v[120:121], v10 offset:40960
    v_mfma_f32_16x16x32_bf16 v[164:167], v[76:79], v[60:63], v[164:167]
    ds_read_b64_tr_b16 v[122:123], v10 offset:41728
    v_mfma_f32_16x16x32_bf16 v[188:191], v[76:79], v[64:67], v[188:191]
    ds_read_b64_tr_b16 v[124:125], v10 offset:53248
    v_mfma_f32_16x16x32_bf16 v[212:215], v[76:79], v[68:71], v[212:215]
    ds_read_b64_tr_b16 v[126:127], v10 offset:54016
    v_mfma_f32_16x16x32_bf16 v[144:147], v[80:83], v[56:59], v[144:147]
    v_mfma_f32_16x16x32_bf16 v[168:171], v[80:83], v[60:63], v[168:171]
    ds_read_b64_tr_b16 v[128:129], v11 offset:40960
    v_mfma_f32_16x16x32_bf16 v[192:195], v[80:83], v[64:67], v[192:195]
    ds_read_b64_tr_b16 v[130:131], v11 offset:41728
    v_mfma_f32_16x16x32_bf16 v[216:219], v[80:83], v[68:71], v[216:219]
    ds_read_b64_tr_b16 v[132:133], v11 offset:53248
    v_mfma_f32_16x16x32_bf16 v[148:151], v[84:87], v[56:59], v[148:151]
    ds_read_b64_tr_b16 v[134:135], v11 offset:54016
    v_mfma_f32_16x16x32_bf16 v[172:175], v[84:87], v[60:63], v[172:175]
    v_mfma_f32_16x16x32_bf16 v[196:199], v[84:87], v[64:67], v[196:199]
    v_mfma_f32_16x16x32_bf16 v[220:223], v[84:87], v[68:71], v[220:223]
    v_mfma_f32_16x16x32_bf16 v[152:155], v[88:91], v[56:59], v[152:155]
    v_mfma_f32_16x16x32_bf16 v[176:179], v[88:91], v[60:63], v[176:179]
    v_mfma_f32_16x16x32_bf16 v[200:203], v[88:91], v[64:67], v[200:203]
    v_mfma_f32_16x16x32_bf16 v[224:227], v[88:91], v[68:71], v[224:227]
    v_mfma_f32_16x16x32_bf16 v[156:159], v[92:95], v[56:59], v[156:159]
    v_mfma_f32_16x16x32_bf16 v[180:183], v[92:95], v[60:63], v[180:183]
    v_mfma_f32_16x16x32_bf16 v[204:207], v[92:95], v[64:67], v[204:207]
    v_mfma_f32_16x16x32_bf16 v[228:231], v[92:95], v[68:71], v[228:231]
    s_waitcnt lgkmcnt(0)
    s_barrier
    v_mfma_f32_16x16x32_bf16 v[136:139], v[112:115], v[96:99], v[136:139]
    ds_read_b64_tr_b16 v[72:73], v12
    v_mfma_f32_16x16x32_bf16 v[160:163], v[112:115], v[100:103], v[160:163]
    ds_read_b64_tr_b16 v[74:75], v12 offset:768
    v_mfma_f32_16x16x32_bf16 v[184:187], v[112:115], v[104:107], v[184:187]
    ds_read_b128 v[56:59], v4
    v_mfma_f32_16x16x32_bf16 v[208:211], v[112:115], v[108:111], v[208:211]
    ds_read_b128 v[60:63], v4 offset:2048
    v_mfma_f32_16x16x32_bf16 v[140:143], v[116:119], v[96:99], v[140:143]
    ds_read_b128 v[64:67], v4 offset:4096
    v_mfma_f32_16x16x32_bf16 v[164:167], v[116:119], v[100:103], v[164:167]
    ds_read_b128 v[68:71], v4 offset:6144
    v_mfma_f32_16x16x32_bf16 v[188:191], v[116:119], v[104:107], v[188:191]
    ds_read_b64_tr_b16 v[76:77], v12 offset:12288
    v_mfma_f32_16x16x32_bf16 v[212:215], v[116:119], v[108:111], v[212:215]
    ds_read_b64_tr_b16 v[78:79], v12 offset:13056
    v_mfma_f32_16x16x32_bf16 v[144:147], v[120:123], v[96:99], v[144:147]
    ds_read_b64_tr_b16 v[80:81], v13
    v_mfma_f32_16x16x32_bf16 v[168:171], v[120:123], v[100:103], v[168:171]
    ds_read_b64_tr_b16 v[82:83], v13 offset:768
    v_mfma_f32_16x16x32_bf16 v[192:195], v[120:123], v[104:107], v[192:195]
    ds_read_b64_tr_b16 v[84:85], v13 offset:12288
    v_mfma_f32_16x16x32_bf16 v[216:219], v[120:123], v[108:111], v[216:219]
    ds_read_b64_tr_b16 v[86:87], v13 offset:13056
    v_mfma_f32_16x16x32_bf16 v[148:151], v[124:127], v[96:99], v[148:151]
    ds_read_b64_tr_b16 v[88:89], v14
    v_mfma_f32_16x16x32_bf16 v[172:175], v[124:127], v[100:103], v[172:175]
    ds_read_b64_tr_b16 v[90:91], v14 offset:768
    v_mfma_f32_16x16x32_bf16 v[196:199], v[124:127], v[104:107], v[196:199]
    ds_read_b64_tr_b16 v[92:93], v14 offset:12288
    v_mfma_f32_16x16x32_bf16 v[220:223], v[124:127], v[108:111], v[220:223]
    ds_read_b64_tr_b16 v[94:95], v14 offset:13056
    v_mfma_f32_16x16x32_bf16 v[152:155], v[128:131], v[96:99], v[152:155]
    v_mfma_f32_16x16x32_bf16 v[176:179], v[128:131], v[100:103], v[176:179]
    v_mfma_f32_16x16x32_bf16 v[200:203], v[128:131], v[104:107], v[200:203]
    v_mfma_f32_16x16x32_bf16 v[224:227], v[128:131], v[108:111], v[224:227]
    v_mfma_f32_16x16x32_bf16 v[156:159], v[132:135], v[96:99], v[156:159]
    v_mfma_f32_16x16x32_bf16 v[180:183], v[132:135], v[100:103], v[180:183]
    v_mfma_f32_16x16x32_bf16 v[204:207], v[132:135], v[104:107], v[204:207]
    v_mfma_f32_16x16x32_bf16 v[228:231], v[132:135], v[108:111], v[228:231]
    s_waitcnt lgkmcnt(0)
    .p2align 3
    v_mfma_f32_16x16x32_bf16 v[20:23], v[24:27], v[72:75], v[20:23]
    ds_read_b64_tr_b16 v[112:113], v15
    v_mfma_f32_16x16x32_bf16 v[20:23], v[28:31], v[76:79], v[20:23]
    ds_read_b64_tr_b16 v[114:115], v15 offset:768
    v_mfma_f32_16x16x32_bf16 v[20:23], v[32:35], v[80:83], v[20:23]
    ds_read_b128 v[96:99], v5
    v_mfma_f32_16x16x32_bf16 v[20:23], v[36:39], v[84:87], v[20:23]
    ds_read_b128 v[100:103], v5 offset:2048
    v_mfma_f32_16x16x32_bf16 v[20:23], v[40:43], v[88:91], v[20:23]
    v_mfma_f32_16x16x32_bf16 v[20:23], v[44:47], v[92:95], v[20:23]
    ds_read_b128 v[104:107], v5 offset:4096
    v_mfma_f32_16x16x32_bf16 v[136:139], v[72:75], v[56:59], v[136:139]
    ds_read_b128 v[108:111], v5 offset:6144
    v_mfma_f32_16x16x32_bf16 v[160:163], v[72:75], v[60:63], v[160:163]
    ds_read_b64_tr_b16 v[116:117], v15 offset:12288
    v_mfma_f32_16x16x32_bf16 v[184:187], v[72:75], v[64:67], v[184:187]
    ds_read_b64_tr_b16 v[118:119], v15 offset:13056
    v_mfma_f32_16x16x32_bf16 v[208:211], v[72:75], v[68:71], v[208:211]
    v_mfma_f32_16x16x32_bf16 v[140:143], v[76:79], v[56:59], v[140:143]
    ds_read_b64_tr_b16 v[120:121], v16
    v_mfma_f32_16x16x32_bf16 v[164:167], v[76:79], v[60:63], v[164:167]
    ds_read_b64_tr_b16 v[122:123], v16 offset:768
    v_mfma_f32_16x16x32_bf16 v[188:191], v[76:79], v[64:67], v[188:191]
    ds_read_b64_tr_b16 v[124:125], v16 offset:12288
    v_mfma_f32_16x16x32_bf16 v[212:215], v[76:79], v[68:71], v[212:215]
    ds_read_b64_tr_b16 v[126:127], v16 offset:13056
    v_mfma_f32_16x16x32_bf16 v[144:147], v[80:83], v[56:59], v[144:147]
    v_mfma_f32_16x16x32_bf16 v[168:171], v[80:83], v[60:63], v[168:171]
    ds_read_b64_tr_b16 v[128:129], v17
    v_mfma_f32_16x16x32_bf16 v[192:195], v[80:83], v[64:67], v[192:195]
    ds_read_b64_tr_b16 v[130:131], v17 offset:768
    v_mfma_f32_16x16x32_bf16 v[216:219], v[80:83], v[68:71], v[216:219]
    ds_read_b64_tr_b16 v[132:133], v17 offset:12288
    v_mfma_f32_16x16x32_bf16 v[148:151], v[84:87], v[56:59], v[148:151]
    ds_read_b64_tr_b16 v[134:135], v17 offset:13056
    v_mfma_f32_16x16x32_bf16 v[172:175], v[84:87], v[60:63], v[172:175]
    v_mfma_f32_16x16x32_bf16 v[196:199], v[84:87], v[64:67], v[196:199]
    v_mfma_f32_16x16x32_bf16 v[220:223], v[84:87], v[68:71], v[220:223]
    v_mfma_f32_16x16x32_bf16 v[152:155], v[88:91], v[56:59], v[152:155]
    v_mfma_f32_16x16x32_bf16 v[176:179], v[88:91], v[60:63], v[176:179]
    v_mfma_f32_16x16x32_bf16 v[200:203], v[88:91], v[64:67], v[200:203]
    v_mfma_f32_16x16x32_bf16 v[224:227], v[88:91], v[68:71], v[224:227]
    v_mfma_f32_16x16x32_bf16 v[156:159], v[92:95], v[56:59], v[156:159]
    v_mfma_f32_16x16x32_bf16 v[180:183], v[92:95], v[60:63], v[180:183]
    v_mfma_f32_16x16x32_bf16 v[204:207], v[92:95], v[64:67], v[204:207]
    v_mfma_f32_16x16x32_bf16 v[228:231], v[92:95], v[68:71], v[228:231]
    s_waitcnt lgkmcnt(0)
    s_barrier
    v_mfma_f32_16x16x32_bf16 v[136:139], v[112:115], v[96:99], v[136:139]
    ds_read_b64_tr_b16 v[72:73], v12 offset:40960
    v_mfma_f32_16x16x32_bf16 v[160:163], v[112:115], v[100:103], v[160:163]
    ds_read_b64_tr_b16 v[74:75], v12 offset:41728
    v_mfma_f32_16x16x32_bf16 v[184:187], v[112:115], v[104:107], v[184:187]
    ds_read_b128 v[56:59], v4 offset:40960
    v_mfma_f32_16x16x32_bf16 v[208:211], v[112:115], v[108:111], v[208:211]
    ds_read_b128 v[60:63], v4 offset:43008
    v_mfma_f32_16x16x32_bf16 v[140:143], v[116:119], v[96:99], v[140:143]
    ds_read_b128 v[64:67], v4 offset:45056
    v_mfma_f32_16x16x32_bf16 v[164:167], v[116:119], v[100:103], v[164:167]
    ds_read_b128 v[68:71], v4 offset:47104
    v_mfma_f32_16x16x32_bf16 v[188:191], v[116:119], v[104:107], v[188:191]
    ds_read_b64_tr_b16 v[76:77], v12 offset:53248
    v_mfma_f32_16x16x32_bf16 v[212:215], v[116:119], v[108:111], v[212:215]
    ds_read_b64_tr_b16 v[78:79], v12 offset:54016
    v_mfma_f32_16x16x32_bf16 v[144:147], v[120:123], v[96:99], v[144:147]
    ds_read_b64_tr_b16 v[80:81], v13 offset:40960
    v_mfma_f32_16x16x32_bf16 v[168:171], v[120:123], v[100:103], v[168:171]
    ds_read_b64_tr_b16 v[82:83], v13 offset:41728
    v_mfma_f32_16x16x32_bf16 v[192:195], v[120:123], v[104:107], v[192:195]
    ds_read_b64_tr_b16 v[84:85], v13 offset:53248
    v_mfma_f32_16x16x32_bf16 v[216:219], v[120:123], v[108:111], v[216:219]
    ds_read_b64_tr_b16 v[86:87], v13 offset:54016
    v_mfma_f32_16x16x32_bf16 v[148:151], v[124:127], v[96:99], v[148:151]
    ds_read_b64_tr_b16 v[88:89], v14 offset:40960
    v_mfma_f32_16x16x32_bf16 v[172:175], v[124:127], v[100:103], v[172:175]
    ds_read_b64_tr_b16 v[90:91], v14 offset:41728
    v_mfma_f32_16x16x32_bf16 v[196:199], v[124:127], v[104:107], v[196:199]
    ds_read_b64_tr_b16 v[92:93], v14 offset:53248
    v_mfma_f32_16x16x32_bf16 v[220:223], v[124:127], v[108:111], v[220:223]
    ds_read_b64_tr_b16 v[94:95], v14 offset:54016
    v_mfma_f32_16x16x32_bf16 v[152:155], v[128:131], v[96:99], v[152:155]
    v_mfma_f32_16x16x32_bf16 v[176:179], v[128:131], v[100:103], v[176:179]
    v_mfma_f32_16x16x32_bf16 v[200:203], v[128:131], v[104:107], v[200:203]
    v_mfma_f32_16x16x32_bf16 v[224:227], v[128:131], v[108:111], v[224:227]
    v_mfma_f32_16x16x32_bf16 v[156:159], v[132:135], v[96:99], v[156:159]
    v_mfma_f32_16x16x32_bf16 v[180:183], v[132:135], v[100:103], v[180:183]
    v_mfma_f32_16x16x32_bf16 v[204:207], v[132:135], v[104:107], v[204:207]
    v_mfma_f32_16x16x32_bf16 v[228:231], v[132:135], v[108:111], v[228:231]
    s_waitcnt lgkmcnt(0)
    .p2align 3
    v_mfma_f32_16x16x32_bf16 v[20:23], v[24:27], v[72:75], v[20:23]
    ds_read_b64_tr_b16 v[112:113], v15 offset:40960
    v_mfma_f32_16x16x32_bf16 v[20:23], v[28:31], v[76:79], v[20:23]
    ds_read_b64_tr_b16 v[114:115], v15 offset:41728
    v_mfma_f32_16x16x32_bf16 v[20:23], v[32:35], v[80:83], v[20:23]
    ds_read_b128 v[96:99], v5 offset:40960
    v_mfma_f32_16x16x32_bf16 v[20:23], v[36:39], v[84:87], v[20:23]
    ds_read_b128 v[100:103], v5 offset:43008
    v_mfma_f32_16x16x32_bf16 v[20:23], v[40:43], v[88:91], v[20:23]
    v_mfma_f32_16x16x32_bf16 v[20:23], v[44:47], v[92:95], v[20:23]
    ds_read_b128 v[104:107], v5 offset:45056
    v_mfma_f32_16x16x32_bf16 v[136:139], v[72:75], v[56:59], v[136:139]
    ds_read_b128 v[108:111], v5 offset:47104
    v_mfma_f32_16x16x32_bf16 v[160:163], v[72:75], v[60:63], v[160:163]
    ds_read_b64_tr_b16 v[116:117], v15 offset:53248
    v_mfma_f32_16x16x32_bf16 v[184:187], v[72:75], v[64:67], v[184:187]
    ds_read_b64_tr_b16 v[118:119], v15 offset:54016
    v_mfma_f32_16x16x32_bf16 v[208:211], v[72:75], v[68:71], v[208:211]
    v_mfma_f32_16x16x32_bf16 v[140:143], v[76:79], v[56:59], v[140:143]
    ds_read_b64_tr_b16 v[120:121], v16 offset:40960
    v_mfma_f32_16x16x32_bf16 v[164:167], v[76:79], v[60:63], v[164:167]
    ds_read_b64_tr_b16 v[122:123], v16 offset:41728
    v_mfma_f32_16x16x32_bf16 v[188:191], v[76:79], v[64:67], v[188:191]
    ds_read_b64_tr_b16 v[124:125], v16 offset:53248
    v_mfma_f32_16x16x32_bf16 v[212:215], v[76:79], v[68:71], v[212:215]
    ds_read_b64_tr_b16 v[126:127], v16 offset:54016
    v_mfma_f32_16x16x32_bf16 v[144:147], v[80:83], v[56:59], v[144:147]
    ds_write2st64_b32 v51, v20, v21 offset1:1
    v_mfma_f32_16x16x32_bf16 v[168:171], v[80:83], v[60:63], v[168:171]
    ds_read_b64_tr_b16 v[128:129], v17 offset:40960
    v_mfma_f32_16x16x32_bf16 v[192:195], v[80:83], v[64:67], v[192:195]
    ds_read_b64_tr_b16 v[130:131], v17 offset:41728
    v_mfma_f32_16x16x32_bf16 v[216:219], v[80:83], v[68:71], v[216:219]
    ds_read_b64_tr_b16 v[132:133], v17 offset:53248
    v_mfma_f32_16x16x32_bf16 v[148:151], v[84:87], v[56:59], v[148:151]
    ds_read_b64_tr_b16 v[134:135], v17 offset:54016
    v_mfma_f32_16x16x32_bf16 v[172:175], v[84:87], v[60:63], v[172:175]
    v_mfma_f32_16x16x32_bf16 v[196:199], v[84:87], v[64:67], v[196:199]
    v_mfma_f32_16x16x32_bf16 v[220:223], v[84:87], v[68:71], v[220:223]
    v_mfma_f32_16x16x32_bf16 v[152:155], v[88:91], v[56:59], v[152:155]
    v_mfma_f32_16x16x32_bf16 v[176:179], v[88:91], v[60:63], v[176:179]
    v_mfma_f32_16x16x32_bf16 v[200:203], v[88:91], v[64:67], v[200:203]
    v_mfma_f32_16x16x32_bf16 v[224:227], v[88:91], v[68:71], v[224:227]
    v_mfma_f32_16x16x32_bf16 v[156:159], v[92:95], v[56:59], v[156:159]
    v_mfma_f32_16x16x32_bf16 v[180:183], v[92:95], v[60:63], v[180:183]
    v_mfma_f32_16x16x32_bf16 v[204:207], v[92:95], v[64:67], v[204:207]
    v_mfma_f32_16x16x32_bf16 v[228:231], v[92:95], v[68:71], v[228:231]
    s_waitcnt lgkmcnt(0)
    s_barrier
    v_mfma_f32_16x16x32_bf16 v[136:139], v[112:115], v[96:99], v[136:139]
    ds_read_b128 v[232:235], v18
    ds_read_b128 v[236:239], v18 offset:256
    v_mfma_f32_16x16x32_bf16 v[160:163], v[112:115], v[100:103], v[160:163]
    ds_read_b128 v[240:243], v18 offset:512
    v_mfma_f32_16x16x32_bf16 v[184:187], v[112:115], v[104:107], v[184:187]
    ds_read_b128 v[244:247], v18 offset:768
    v_mfma_f32_16x16x32_bf16 v[208:211], v[112:115], v[108:111], v[208:211]
    ds_read_b128 v[24:27], v19
    v_mfma_f32_16x16x32_bf16 v[140:143], v[116:119], v[96:99], v[140:143]
    ds_read_b128 v[28:31], v19 offset:64
    v_mfma_f32_16x16x32_bf16 v[164:167], v[116:119], v[100:103], v[164:167]
    ds_read_b128 v[32:35], v19 offset:128
    v_mfma_f32_16x16x32_bf16 v[188:191], v[116:119], v[104:107], v[188:191]
    ds_read_b128 v[36:39], v19 offset:192
    v_mfma_f32_16x16x32_bf16 v[212:215], v[116:119], v[108:111], v[212:215]
    ds_read_b128 v[40:43], v19 offset:256
    v_mfma_f32_16x16x32_bf16 v[144:147], v[120:123], v[96:99], v[144:147]
    ds_read_b128 v[44:47], v19 offset:320
    v_mfma_f32_16x16x32_bf16 v[168:171], v[120:123], v[100:103], v[168:171]
    ds_read_b128 v[56:59], v19 offset:512
    v_mfma_f32_16x16x32_bf16 v[192:195], v[120:123], v[104:107], v[192:195]
    ds_read_b128 v[60:63], v19 offset:576
    v_mfma_f32_16x16x32_bf16 v[216:219], v[120:123], v[108:111], v[216:219]
    ds_read_b128 v[64:67], v19 offset:640
    v_mfma_f32_16x16x32_bf16 v[148:151], v[124:127], v[96:99], v[148:151]
    ds_read_b128 v[68:71], v19 offset:704
    v_mfma_f32_16x16x32_bf16 v[172:175], v[124:127], v[100:103], v[172:175]
    ds_read_b128 v[72:75], v19 offset:768
    v_mfma_f32_16x16x32_bf16 v[196:199], v[124:127], v[104:107], v[196:199]
    ds_read_b128 v[76:79], v19 offset:832
    v_mfma_f32_16x16x32_bf16 v[220:223], v[124:127], v[108:111], v[220:223]
    ds_read_b32 v53, v52
    v_mfma_f32_16x16x32_bf16 v[152:155], v[128:131], v[96:99], v[152:155]
    v_mfma_f32_16x16x32_bf16 v[176:179], v[128:131], v[100:103], v[176:179]
    v_mfma_f32_16x16x32_bf16 v[200:203], v[128:131], v[104:107], v[200:203]
    v_mfma_f32_16x16x32_bf16 v[224:227], v[128:131], v[108:111], v[224:227]
    v_mfma_f32_16x16x32_bf16 v[156:159], v[132:135], v[96:99], v[156:159]
    v_mfma_f32_16x16x32_bf16 v[180:183], v[132:135], v[100:103], v[180:183]
    v_mfma_f32_16x16x32_bf16 v[204:207], v[132:135], v[104:107], v[204:207]
    v_mfma_f32_16x16x32_bf16 v[228:231], v[132:135], v[108:111], v[228:231]
    s_waitcnt lgkmcnt(0)
    .p2align 3
    v_pk_add_f32 v[24:25], v[24:25], v[56:57]
    v_pk_add_f32 v[26:27], v[26:27], v[58:59]
    v_pk_add_f32 v[28:29], v[28:29], v[60:61]
    v_pk_add_f32 v[30:31], v[30:31], v[62:63]
    v_pk_add_f32 v[32:33], v[32:33], v[64:65]
    v_pk_add_f32 v[34:35], v[34:35], v[66:67]
    v_pk_add_f32 v[36:37], v[36:37], v[68:69]
    v_pk_add_f32 v[38:39], v[38:39], v[70:71]
    v_pk_add_f32 v[40:41], v[40:41], v[72:73]
    v_pk_add_f32 v[42:43], v[42:43], v[74:75]
    v_pk_add_f32 v[44:45], v[44:45], v[76:77]
    v_pk_add_f32 v[46:47], v[46:47], v[78:79]
    v_pk_fma_f32 v[136:137], v[24:25], v[232:233], v[136:137] op_sel_hi:[1,0,1]
    v_pk_fma_f32 v[138:139], v[26:27], v[232:233], v[138:139] op_sel_hi:[1,0,1]
    v_pk_fma_f32 v[160:161], v[24:25], v[236:237], v[160:161] op_sel_hi:[1,0,1]
    v_pk_fma_f32 v[162:163], v[26:27], v[236:237], v[162:163] op_sel_hi:[1,0,1]
    v_pk_mul_f32 v[56:57], v[136:137], v[136:137]
    v_pk_mul_f32 v[58:59], v[138:139], v[138:139]
    v_pk_mul_f32 v[60:61], v[160:161], v[160:161]
    v_pk_mul_f32 v[62:63], v[162:163], v[162:163]
    v_pk_fma_f32 v[56:57], v[56:57], v[234:235], v[234:235] op_sel:[0,0,1] op_sel_hi:[1,0,1]
    v_pk_fma_f32 v[58:59], v[58:59], v[234:235], v[234:235] op_sel:[0,0,1] op_sel_hi:[1,0,1]
    v_pk_fma_f32 v[60:61], v[60:61], v[238:239], v[238:239] op_sel:[0,0,1] op_sel_hi:[1,0,1]
    v_pk_fma_f32 v[62:63], v[62:63], v[238:239], v[238:239] op_sel:[0,0,1] op_sel_hi:[1,0,1]
    v_pk_mul_f32 v[56:57], v[56:57], v[136:137]
    v_pk_mul_f32 v[58:59], v[58:59], v[138:139]
    v_pk_mul_f32 v[60:61], v[60:61], v[160:161]
    v_pk_mul_f32 v[62:63], v[62:63], v[162:163]
    v_exp_f32 v56, v56
    v_exp_f32 v57, v57
    v_exp_f32 v58, v58
    v_exp_f32 v59, v59
    v_exp_f32 v60, v60
    v_exp_f32 v61, v61
    v_exp_f32 v62, v62
    v_exp_f32 v63, v63
    v_pk_fma_f32 v[140:141], v[28:29], v[232:233], v[140:141] op_sel_hi:[1,0,1]
    v_pk_fma_f32 v[142:143], v[30:31], v[232:233], v[142:143] op_sel_hi:[1,0,1]
    v_pk_fma_f32 v[164:165], v[28:29], v[236:237], v[164:165] op_sel_hi:[1,0,1]
    v_pk_fma_f32 v[166:167], v[30:31], v[236:237], v[166:167] op_sel_hi:[1,0,1]
    v_pk_fma_f32 v[56:57], v[56:57], v[232:233], v[232:233] op_sel:[0,1,1] op_sel_hi:[1,1,1]
    v_pk_fma_f32 v[58:59], v[58:59], v[232:233], v[232:233] op_sel:[0,1,1] op_sel_hi:[1,1,1]
    v_pk_fma_f32 v[60:61], v[60:61], v[236:237], v[236:237] op_sel:[0,1,1] op_sel_hi:[1,1,1]
    v_pk_fma_f32 v[62:63], v[62:63], v[236:237], v[236:237] op_sel:[0,1,1] op_sel_hi:[1,1,1]
    v_rcp_f32 v56, v56
    v_rcp_f32 v57, v57
    v_rcp_f32 v58, v58
    v_rcp_f32 v59, v59
    v_rcp_f32 v60, v60
    v_rcp_f32 v61, v61
    v_rcp_f32 v62, v62
    v_rcp_f32 v63, v63
    v_pk_mul_f32 v[136:137], v[136:137], v[140:141]
    v_pk_mul_f32 v[138:139], v[138:139], v[142:143]
    v_pk_mul_f32 v[160:161], v[160:161], v[164:165]
    v_pk_mul_f32 v[162:163], v[162:163], v[166:167]
    v_pk_mul_f32 v[136:137], v[136:137], v[56:57]
    v_pk_mul_f32 v[138:139], v[138:139], v[58:59]
    v_pk_mul_f32 v[160:161], v[160:161], v[60:61]
    v_pk_mul_f32 v[162:163], v[162:163], v[62:63]
    v_cvt_pk_bf16_f32 v140, v136, v137
    v_cvt_pk_bf16_f32 v142, v160, v161
    v_cvt_pk_bf16_f32 v141, v138, v139
    v_cvt_pk_bf16_f32 v143, v162, v163
    v_permlane16_swap_b32 v140, v142
    s_nop 0
    v_permlane16_swap_b32 v141, v143
    s_nop 0
    buffer_store_dwordx4 v[140:143], v48, s[52:55], s33 offen sc1
    s_barrier
    s_nop 0
    v_pk_fma_f32 v[184:185], v[24:25], v[240:241], v[184:185] op_sel_hi:[1,0,1]
    v_pk_fma_f32 v[186:187], v[26:27], v[240:241], v[186:187] op_sel_hi:[1,0,1]
    v_pk_fma_f32 v[208:209], v[24:25], v[244:245], v[208:209] op_sel_hi:[1,0,1]
    v_pk_fma_f32 v[210:211], v[26:27], v[244:245], v[210:211] op_sel_hi:[1,0,1]
    v_pk_mul_f32 v[56:57], v[184:185], v[184:185]
    v_pk_mul_f32 v[58:59], v[186:187], v[186:187]
    v_pk_mul_f32 v[60:61], v[208:209], v[208:209]
    v_pk_mul_f32 v[62:63], v[210:211], v[210:211]
    v_pk_fma_f32 v[56:57], v[56:57], v[242:243], v[242:243] op_sel:[0,0,1] op_sel_hi:[1,0,1]
    v_pk_fma_f32 v[58:59], v[58:59], v[242:243], v[242:243] op_sel:[0,0,1] op_sel_hi:[1,0,1]
    v_pk_fma_f32 v[60:61], v[60:61], v[246:247], v[246:247] op_sel:[0,0,1] op_sel_hi:[1,0,1]
    v_pk_fma_f32 v[62:63], v[62:63], v[246:247], v[246:247] op_sel:[0,0,1] op_sel_hi:[1,0,1]
    v_pk_mul_f32 v[56:57], v[56:57], v[184:185]
    v_pk_mul_f32 v[58:59], v[58:59], v[186:187]
    v_pk_mul_f32 v[60:61], v[60:61], v[208:209]
    v_pk_mul_f32 v[62:63], v[62:63], v[210:211]
    v_exp_f32 v56, v56
    v_exp_f32 v57, v57
    v_exp_f32 v58, v58
    v_exp_f32 v59, v59
    v_exp_f32 v60, v60
    v_exp_f32 v61, v61
    v_exp_f32 v62, v62
    v_exp_f32 v63, v63
    v_pk_fma_f32 v[188:189], v[28:29], v[240:241], v[188:189] op_sel_hi:[1,0,1]
    v_pk_fma_f32 v[190:191], v[30:31], v[240:241], v[190:191] op_sel_hi:[1,0,1]
    v_pk_fma_f32 v[212:213], v[28:29], v[244:245], v[212:213] op_sel_hi:[1,0,1]
    v_pk_fma_f32 v[214:215], v[30:31], v[244:245], v[214:215] op_sel_hi:[1,0,1]
    v_pk_fma_f32 v[56:57], v[56:57], v[240:241], v[240:241] op_sel:[0,1,1] op_sel_hi:[1,1,1]
    v_pk_fma_f32 v[58:59], v[58:59], v[240:241], v[240:241] op_sel:[0,1,1] op_sel_hi:[1,1,1]
    v_pk_fma_f32 v[60:61], v[60:61], v[244:245], v[244:245] op_sel:[0,1,1] op_sel_hi:[1,1,1]
    v_pk_fma_f32 v[62:63], v[62:63], v[244:245], v[244:245] op_sel:[0,1,1] op_sel_hi:[1,1,1]
    v_rcp_f32 v56, v56
    v_rcp_f32 v57, v57
    v_rcp_f32 v58, v58
    v_rcp_f32 v59, v59
    v_rcp_f32 v60, v60
    v_rcp_f32 v61, v61
    v_rcp_f32 v62, v62
    v_rcp_f32 v63, v63
    v_pk_mul_f32 v[184:185], v[184:185], v[188:189]
    v_pk_mul_f32 v[186:187], v[186:187], v[190:191]
    v_pk_mul_f32 v[208:209], v[208:209], v[212:213]
    v_pk_mul_f32 v[210:211], v[210:211], v[214:215]
    v_pk_mul_f32 v[184:185], v[184:185], v[56:57]
    v_pk_mul_f32 v[186:187], v[186:187], v[58:59]
    v_pk_mul_f32 v[208:209], v[208:209], v[60:61]
    v_pk_mul_f32 v[210:211], v[210:211], v[62:63]
    v_cvt_pk_bf16_f32 v188, v184, v185
    v_cvt_pk_bf16_f32 v190, v208, v209
    v_cvt_pk_bf16_f32 v189, v186, v187
    v_cvt_pk_bf16_f32 v191, v210, v211
    v_permlane16_swap_b32 v188, v190
    s_nop 0
    v_permlane16_swap_b32 v189, v191
    s_nop 0
    buffer_store_dwordx4 v[188:191], v48, s[52:55], s43 offen sc1
    v_pk_fma_f32 v[144:145], v[32:33], v[232:233], v[144:145] op_sel_hi:[1,0,1]
    v_pk_fma_f32 v[146:147], v[34:35], v[232:233], v[146:147] op_sel_hi:[1,0,1]
    v_pk_fma_f32 v[168:169], v[32:33], v[236:237], v[168:169] op_sel_hi:[1,0,1]
    v_pk_fma_f32 v[170:171], v[34:35], v[236:237], v[170:171] op_sel_hi:[1,0,1]
    v_pk_mul_f32 v[56:57], v[144:145], v[144:145]
    v_pk_mul_f32 v[58:59], v[146:147], v[146:147]
    v_pk_mul_f32 v[60:61], v[168:169], v[168:169]
    v_pk_mul_f32 v[62:63], v[170:171], v[170:171]
    v_pk_fma_f32 v[56:57], v[56:57], v[234:235], v[234:235] op_sel:[0,0,1] op_sel_hi:[1,0,1]
    v_pk_fma_f32 v[58:59], v[58:59], v[234:235], v[234:235] op_sel:[0,0,1] op_sel_hi:[1,0,1]
    v_pk_fma_f32 v[60:61], v[60:61], v[238:239], v[238:239] op_sel:[0,0,1] op_sel_hi:[1,0,1]
    v_pk_fma_f32 v[62:63], v[62:63], v[238:239], v[238:239] op_sel:[0,0,1] op_sel_hi:[1,0,1]
    v_pk_mul_f32 v[56:57], v[56:57], v[144:145]
    v_pk_mul_f32 v[58:59], v[58:59], v[146:147]
    v_pk_mul_f32 v[60:61], v[60:61], v[168:169]
    v_pk_mul_f32 v[62:63], v[62:63], v[170:171]
    v_exp_f32 v56, v56
    v_exp_f32 v57, v57
    v_exp_f32 v58, v58
    v_exp_f32 v59, v59
    v_exp_f32 v60, v60
    v_exp_f32 v61, v61
    v_exp_f32 v62, v62
    v_exp_f32 v63, v63
    v_pk_fma_f32 v[148:149], v[36:37], v[232:233], v[148:149] op_sel_hi:[1,0,1]
    v_pk_fma_f32 v[150:151], v[38:39], v[232:233], v[150:151] op_sel_hi:[1,0,1]
    v_pk_fma_f32 v[172:173], v[36:37], v[236:237], v[172:173] op_sel_hi:[1,0,1]
    v_pk_fma_f32 v[174:175], v[38:39], v[236:237], v[174:175] op_sel_hi:[1,0,1]
    v_pk_fma_f32 v[56:57], v[56:57], v[232:233], v[232:233] op_sel:[0,1,1] op_sel_hi:[1,1,1]
    v_pk_fma_f32 v[58:59], v[58:59], v[232:233], v[232:233] op_sel:[0,1,1] op_sel_hi:[1,1,1]
    v_pk_fma_f32 v[60:61], v[60:61], v[236:237], v[236:237] op_sel:[0,1,1] op_sel_hi:[1,1,1]
    v_pk_fma_f32 v[62:63], v[62:63], v[236:237], v[236:237] op_sel:[0,1,1] op_sel_hi:[1,1,1]
    v_rcp_f32 v56, v56
    v_rcp_f32 v57, v57
    v_rcp_f32 v58, v58
    v_rcp_f32 v59, v59
    v_rcp_f32 v60, v60
    v_rcp_f32 v61, v61
    v_rcp_f32 v62, v62
    v_rcp_f32 v63, v63
    v_pk_mul_f32 v[144:145], v[144:145], v[148:149]
    v_pk_mul_f32 v[146:147], v[146:147], v[150:151]
    v_pk_mul_f32 v[168:169], v[168:169], v[172:173]
    v_pk_mul_f32 v[170:171], v[170:171], v[174:175]
    v_pk_mul_f32 v[144:145], v[144:145], v[56:57]
    v_pk_mul_f32 v[146:147], v[146:147], v[58:59]
    v_pk_mul_f32 v[168:169], v[168:169], v[60:61]
    v_pk_mul_f32 v[170:171], v[170:171], v[62:63]
    v_cvt_pk_bf16_f32 v148, v144, v145
    v_cvt_pk_bf16_f32 v150, v168, v169
    v_cvt_pk_bf16_f32 v149, v146, v147
    v_cvt_pk_bf16_f32 v151, v170, v171
    v_permlane16_swap_b32 v148, v150
    s_nop 0
    v_permlane16_swap_b32 v149, v151
    s_nop 0
    buffer_store_dwordx4 v[148:151], v48, s[52:55], s33 offen offset:1024 sc1
    v_pk_fma_f32 v[192:193], v[32:33], v[240:241], v[192:193] op_sel_hi:[1,0,1]
    v_pk_fma_f32 v[194:195], v[34:35], v[240:241], v[194:195] op_sel_hi:[1,0,1]
    v_pk_fma_f32 v[216:217], v[32:33], v[244:245], v[216:217] op_sel_hi:[1,0,1]
    v_pk_fma_f32 v[218:219], v[34:35], v[244:245], v[218:219] op_sel_hi:[1,0,1]
    v_pk_mul_f32 v[56:57], v[192:193], v[192:193]
    v_pk_mul_f32 v[58:59], v[194:195], v[194:195]
    v_pk_mul_f32 v[60:61], v[216:217], v[216:217]
    v_pk_mul_f32 v[62:63], v[218:219], v[218:219]
    v_pk_fma_f32 v[56:57], v[56:57], v[242:243], v[242:243] op_sel:[0,0,1] op_sel_hi:[1,0,1]
    v_pk_fma_f32 v[58:59], v[58:59], v[242:243], v[242:243] op_sel:[0,0,1] op_sel_hi:[1,0,1]
    v_pk_fma_f32 v[60:61], v[60:61], v[246:247], v[246:247] op_sel:[0,0,1] op_sel_hi:[1,0,1]
    v_pk_fma_f32 v[62:63], v[62:63], v[246:247], v[246:247] op_sel:[0,0,1] op_sel_hi:[1,0,1]
    v_pk_mul_f32 v[56:57], v[56:57], v[192:193]
    v_pk_mul_f32 v[58:59], v[58:59], v[194:195]
    v_pk_mul_f32 v[60:61], v[60:61], v[216:217]
    v_pk_mul_f32 v[62:63], v[62:63], v[218:219]
    v_exp_f32 v56, v56
    v_exp_f32 v57, v57
    v_exp_f32 v58, v58
    v_exp_f32 v59, v59
    v_exp_f32 v60, v60
    v_exp_f32 v61, v61
    v_exp_f32 v62, v62
    v_exp_f32 v63, v63
    v_pk_fma_f32 v[196:197], v[36:37], v[240:241], v[196:197] op_sel_hi:[1,0,1]
    v_pk_fma_f32 v[198:199], v[38:39], v[240:241], v[198:199] op_sel_hi:[1,0,1]
    v_pk_fma_f32 v[220:221], v[36:37], v[244:245], v[220:221] op_sel_hi:[1,0,1]
    v_pk_fma_f32 v[222:223], v[38:39], v[244:245], v[222:223] op_sel_hi:[1,0,1]
    v_pk_fma_f32 v[56:57], v[56:57], v[240:241], v[240:241] op_sel:[0,1,1] op_sel_hi:[1,1,1]
    v_pk_fma_f32 v[58:59], v[58:59], v[240:241], v[240:241] op_sel:[0,1,1] op_sel_hi:[1,1,1]
    v_pk_fma_f32 v[60:61], v[60:61], v[244:245], v[244:245] op_sel:[0,1,1] op_sel_hi:[1,1,1]
    v_pk_fma_f32 v[62:63], v[62:63], v[244:245], v[244:245] op_sel:[0,1,1] op_sel_hi:[1,1,1]
    v_rcp_f32 v56, v56
    v_rcp_f32 v57, v57
    v_rcp_f32 v58, v58
    v_rcp_f32 v59, v59
    v_rcp_f32 v60, v60
    v_rcp_f32 v61, v61
    v_rcp_f32 v62, v62
    v_rcp_f32 v63, v63
    v_pk_mul_f32 v[192:193], v[192:193], v[196:197]
    v_pk_mul_f32 v[194:195], v[194:195], v[198:199]
    v_pk_mul_f32 v[216:217], v[216:217], v[220:221]
    v_pk_mul_f32 v[218:219], v[218:219], v[222:223]
    v_pk_mul_f32 v[192:193], v[192:193], v[56:57]
    v_pk_mul_f32 v[194:195], v[194:195], v[58:59]
    v_pk_mul_f32 v[216:217], v[216:217], v[60:61]
    v_pk_mul_f32 v[218:219], v[218:219], v[62:63]
    v_cvt_pk_bf16_f32 v196, v192, v193
    v_cvt_pk_bf16_f32 v198, v216, v217
    v_cvt_pk_bf16_f32 v197, v194, v195
    v_cvt_pk_bf16_f32 v199, v218, v219
    v_permlane16_swap_b32 v196, v198
    s_nop 0
    v_permlane16_swap_b32 v197, v199
    s_nop 0
    buffer_store_dwordx4 v[196:199], v48, s[52:55], s43 offen offset:1024 sc1
    v_pk_fma_f32 v[152:153], v[40:41], v[232:233], v[152:153] op_sel_hi:[1,0,1]
    v_pk_fma_f32 v[154:155], v[42:43], v[232:233], v[154:155] op_sel_hi:[1,0,1]
    v_pk_fma_f32 v[176:177], v[40:41], v[236:237], v[176:177] op_sel_hi:[1,0,1]
    v_pk_fma_f32 v[178:179], v[42:43], v[236:237], v[178:179] op_sel_hi:[1,0,1]
    v_pk_mul_f32 v[56:57], v[152:153], v[152:153]
    v_pk_mul_f32 v[58:59], v[154:155], v[154:155]
    v_pk_mul_f32 v[60:61], v[176:177], v[176:177]
    v_pk_mul_f32 v[62:63], v[178:179], v[178:179]
    v_pk_fma_f32 v[56:57], v[56:57], v[234:235], v[234:235] op_sel:[0,0,1] op_sel_hi:[1,0,1]
    v_pk_fma_f32 v[58:59], v[58:59], v[234:235], v[234:235] op_sel:[0,0,1] op_sel_hi:[1,0,1]
    v_pk_fma_f32 v[60:61], v[60:61], v[238:239], v[238:239] op_sel:[0,0,1] op_sel_hi:[1,0,1]
    v_pk_fma_f32 v[62:63], v[62:63], v[238:239], v[238:239] op_sel:[0,0,1] op_sel_hi:[1,0,1]
    v_pk_mul_f32 v[56:57], v[56:57], v[152:153]
    v_pk_mul_f32 v[58:59], v[58:59], v[154:155]
    v_pk_mul_f32 v[60:61], v[60:61], v[176:177]
    v_pk_mul_f32 v[62:63], v[62:63], v[178:179]
    v_exp_f32 v56, v56
    v_exp_f32 v57, v57
    v_exp_f32 v58, v58
    v_exp_f32 v59, v59
    v_exp_f32 v60, v60
    v_exp_f32 v61, v61
    v_exp_f32 v62, v62
    v_exp_f32 v63, v63
    v_pk_fma_f32 v[156:157], v[44:45], v[232:233], v[156:157] op_sel_hi:[1,0,1]
    v_pk_fma_f32 v[158:159], v[46:47], v[232:233], v[158:159] op_sel_hi:[1,0,1]
    v_pk_fma_f32 v[180:181], v[44:45], v[236:237], v[180:181] op_sel_hi:[1,0,1]
    v_pk_fma_f32 v[182:183], v[46:47], v[236:237], v[182:183] op_sel_hi:[1,0,1]
    v_pk_fma_f32 v[56:57], v[56:57], v[232:233], v[232:233] op_sel:[0,1,1] op_sel_hi:[1,1,1]
    v_pk_fma_f32 v[58:59], v[58:59], v[232:233], v[232:233] op_sel:[0,1,1] op_sel_hi:[1,1,1]
    v_pk_fma_f32 v[60:61], v[60:61], v[236:237], v[236:237] op_sel:[0,1,1] op_sel_hi:[1,1,1]
    v_pk_fma_f32 v[62:63], v[62:63], v[236:237], v[236:237] op_sel:[0,1,1] op_sel_hi:[1,1,1]
    v_rcp_f32 v56, v56
    v_rcp_f32 v57, v57
    v_rcp_f32 v58, v58
    v_rcp_f32 v59, v59
    v_rcp_f32 v60, v60
    v_rcp_f32 v61, v61
    v_rcp_f32 v62, v62
    v_rcp_f32 v63, v63
    v_pk_mul_f32 v[152:153], v[152:153], v[156:157]
    v_pk_mul_f32 v[154:155], v[154:155], v[158:159]
    v_pk_mul_f32 v[176:177], v[176:177], v[180:181]
    v_pk_mul_f32 v[178:179], v[178:179], v[182:183]
    v_pk_mul_f32 v[152:153], v[152:153], v[56:57]
    v_pk_mul_f32 v[154:155], v[154:155], v[58:59]
    v_pk_mul_f32 v[176:177], v[176:177], v[60:61]
    v_pk_mul_f32 v[178:179], v[178:179], v[62:63]
    v_cvt_pk_bf16_f32 v156, v152, v153
    v_cvt_pk_bf16_f32 v158, v176, v177
    v_cvt_pk_bf16_f32 v157, v154, v155
    v_cvt_pk_bf16_f32 v159, v178, v179
    v_permlane16_swap_b32 v156, v158
    s_nop 0
    v_permlane16_swap_b32 v157, v159
    s_nop 0
    buffer_store_dwordx4 v[156:159], v48, s[52:55], s33 offen offset:2048 sc1
    v_pk_fma_f32 v[200:201], v[40:41], v[240:241], v[200:201] op_sel_hi:[1,0,1]
    v_pk_fma_f32 v[202:203], v[42:43], v[240:241], v[202:203] op_sel_hi:[1,0,1]
    v_pk_fma_f32 v[224:225], v[40:41], v[244:245], v[224:225] op_sel_hi:[1,0,1]
    v_pk_fma_f32 v[226:227], v[42:43], v[244:245], v[226:227] op_sel_hi:[1,0,1]
    v_pk_mul_f32 v[56:57], v[200:201], v[200:201]
    v_pk_mul_f32 v[58:59], v[202:203], v[202:203]
    v_pk_mul_f32 v[60:61], v[224:225], v[224:225]
    v_pk_mul_f32 v[62:63], v[226:227], v[226:227]
    v_pk_fma_f32 v[56:57], v[56:57], v[242:243], v[242:243] op_sel:[0,0,1] op_sel_hi:[1,0,1]
    v_pk_fma_f32 v[58:59], v[58:59], v[242:243], v[242:243] op_sel:[0,0,1] op_sel_hi:[1,0,1]
    v_pk_fma_f32 v[60:61], v[60:61], v[246:247], v[246:247] op_sel:[0,0,1] op_sel_hi:[1,0,1]
    v_pk_fma_f32 v[62:63], v[62:63], v[246:247], v[246:247] op_sel:[0,0,1] op_sel_hi:[1,0,1]
    v_pk_mul_f32 v[56:57], v[56:57], v[200:201]
    v_pk_mul_f32 v[58:59], v[58:59], v[202:203]
    v_pk_mul_f32 v[60:61], v[60:61], v[224:225]
    v_pk_mul_f32 v[62:63], v[62:63], v[226:227]
    v_exp_f32 v56, v56
    v_exp_f32 v57, v57
    v_exp_f32 v58, v58
    v_exp_f32 v59, v59
    v_exp_f32 v60, v60
    v_exp_f32 v61, v61
    v_exp_f32 v62, v62
    v_exp_f32 v63, v63
    v_pk_fma_f32 v[204:205], v[44:45], v[240:241], v[204:205] op_sel_hi:[1,0,1]
    v_pk_fma_f32 v[206:207], v[46:47], v[240:241], v[206:207] op_sel_hi:[1,0,1]
    v_pk_fma_f32 v[228:229], v[44:45], v[244:245], v[228:229] op_sel_hi:[1,0,1]
    v_pk_fma_f32 v[230:231], v[46:47], v[244:245], v[230:231] op_sel_hi:[1,0,1]
    v_pk_fma_f32 v[56:57], v[56:57], v[240:241], v[240:241] op_sel:[0,1,1] op_sel_hi:[1,1,1]
    v_pk_fma_f32 v[58:59], v[58:59], v[240:241], v[240:241] op_sel:[0,1,1] op_sel_hi:[1,1,1]
    v_pk_fma_f32 v[60:61], v[60:61], v[244:245], v[244:245] op_sel:[0,1,1] op_sel_hi:[1,1,1]
    v_pk_fma_f32 v[62:63], v[62:63], v[244:245], v[244:245] op_sel:[0,1,1] op_sel_hi:[1,1,1]
    v_rcp_f32 v56, v56
    v_rcp_f32 v57, v57
    v_rcp_f32 v58, v58
    v_rcp_f32 v59, v59
    v_rcp_f32 v60, v60
    v_rcp_f32 v61, v61
    v_rcp_f32 v62, v62
    v_rcp_f32 v63, v63
    v_pk_mul_f32 v[200:201], v[200:201], v[204:205]
    v_pk_mul_f32 v[202:203], v[202:203], v[206:207]
    v_pk_mul_f32 v[224:225], v[224:225], v[228:229]
    v_pk_mul_f32 v[226:227], v[226:227], v[230:231]
    v_pk_mul_f32 v[200:201], v[200:201], v[56:57]
    v_pk_mul_f32 v[202:203], v[202:203], v[58:59]
    v_pk_mul_f32 v[224:225], v[224:225], v[60:61]
    v_pk_mul_f32 v[226:227], v[226:227], v[62:63]
    v_cvt_pk_bf16_f32 v204, v200, v201
    v_cvt_pk_bf16_f32 v206, v224, v225
    v_cvt_pk_bf16_f32 v205, v202, v203
    v_cvt_pk_bf16_f32 v207, v226, v227
    v_permlane16_swap_b32 v204, v206
    s_nop 0
    v_permlane16_swap_b32 v205, v207
    s_nop 0
    buffer_store_dwordx4 v[204:207], v48, s[52:55], s43 offen offset:2048 sc1
L_p2c:
    v_lshrrev_b32 v16, 4, v1
    v_and_b32 v18, 1, v16
    v_bfe_u32 v20, v1, 3, 1
    v_lshl_add_u32 v20, v18, 1, v20
    v_xor_b32 v20, 2, v20
    v_lshlrev_b32 v20, 5, v20
    v_bfe_u32 v21, v1, 2, 2
    v_lshl_add_u32 v20, v21, 7, v20
    v_and_b32 v21, 3, v1
    v_lshl_add_u32 v20, v21, 3, v20
    v_lshl_add_u32 v2, v16, 10, v20
    s_and_b32 s35, s23, 1
    s_lshl_b32 s35, s35, 12
    s_add_u32 s35, s35, 8192
    v_add_u32 v2, s35, v2
    v_xor_b32 v3, 32, v2
    v_xor_b32 v4, 64, v2
    v_xor_b32 v5, 96, v2
    v_add_u32 v6, 0xc000, v2
    v_add_u32 v7, 0xc000, v3
    v_add_u32 v8, 0xc000, v4
    v_add_u32 v9, 0xc000, v5
    v_add_u32 v10, 0x18000, v2
    v_add_u32 v11, 0x18000, v3
    v_add_u32 v12, 0x18000, v4
    v_add_u32 v13, 0x18000, v5
    ds_read_b64_tr_b16 v[120:121], v2 offset:4096
    ds_read_b64_tr_b16 v[122:123], v2 offset:4608
    ds_read_b64_tr_b16 v[124:125], v3 offset:4096
    ds_read_b64_tr_b16 v[126:127], v3 offset:4608
    ds_read_b64_tr_b16 v[128:129], v4 offset:4096
    ds_read_b64_tr_b16 v[130:131], v4 offset:4608
    ds_read_b64_tr_b16 v[132:133], v5 offset:4096
    ds_read_b64_tr_b16 v[134:135], v5 offset:4608
    ds_read_b64_tr_b16 v[136:137], v2 offset:20480
    ds_read_b64_tr_b16 v[138:139], v2 offset:20992
    ds_read_b64_tr_b16 v[140:141], v3 offset:20480
    ds_read_b64_tr_b16 v[142:143], v3 offset:20992
    ds_read_b64_tr_b16 v[144:145], v4 offset:20480
    ds_read_b64_tr_b16 v[146:147], v4 offset:20992
    ds_read_b64_tr_b16 v[148:149], v5 offset:20480
    ds_read_b64_tr_b16 v[150:151], v5 offset:20992
    ds_read_b64_tr_b16 v[152:153], v2 offset:36864
    ds_read_b64_tr_b16 v[154:155], v2 offset:37376
    ds_read_b64_tr_b16 v[156:157], v3 offset:36864
    ds_read_b64_tr_b16 v[158:159], v3 offset:37376
    ds_read_b64_tr_b16 v[160:161], v4 offset:36864
    ds_read_b64_tr_b16 v[162:163], v4 offset:37376
    ds_read_b64_tr_b16 v[164:165], v5 offset:36864
    ds_read_b64_tr_b16 v[166:167], v5 offset:37376
    v_readfirstlane_b32 s41, v53
    s_waitcnt vmcnt(0) lgkmcnt(0)
    s_barrier
    s_mov_b64 exec, 1
    buffer_store_dword v53, off, s[52:55], s82 sc1
    s_mov_b64 exec, -1
    ds_read_b64_tr_b16 v[168:169], v6 offset:4096
    ds_read_b64_tr_b16 v[170:171], v6 offset:4608
    ds_read_b64_tr_b16 v[172:173], v7 offset:4096
    ds_read_b64_tr_b16 v[174:175], v7 offset:4608
    ds_read_b64_tr_b16 v[176:177], v8 offset:4096
    ds_read_b64_tr_b16 v[178:179], v8 offset:4608
    ds_read_b64_tr_b16 v[180:181], v9 offset:4096
    ds_read_b64_tr_b16 v[182:183], v9 offset:4608
    ds_read_b64_tr_b16 v[184:185], v6 offset:20480
    ds_read_b64_tr_b16 v[186:187], v6 offset:20992
    ds_read_b64_tr_b16 v[188:189], v7 offset:20480
    ds_read_b64_tr_b16 v[190:191], v7 offset:20992
    ds_read_b64_tr_b16 v[192:193], v8 offset:20480
    ds_read_b64_tr_b16 v[194:195], v8 offset:20992
    ds_read_b64_tr_b16 v[196:197], v9 offset:20480
    ds_read_b64_tr_b16 v[198:199], v9 offset:20992
    ds_read_b64_tr_b16 v[200:201], v6 offset:36864
    ds_read_b64_tr_b16 v[202:203], v6 offset:37376
    ds_read_b64_tr_b16 v[204:205], v7 offset:36864
    ds_read_b64_tr_b16 v[206:207], v7 offset:37376
    ds_read_b64_tr_b16 v[208:209], v8 offset:36864
    ds_read_b64_tr_b16 v[210:211], v8 offset:37376
    ds_read_b64_tr_b16 v[212:213], v9 offset:36864
    ds_read_b64_tr_b16 v[214:215], v9 offset:37376
    s_lshr_b32 s69, s23, 1
    s_and_b32 s27, s23, 1
    v_and_b32 v17, 15, v1
    v_lshrrev_b32 v19, 1, v16
    s_lshl_b32 s38, s69, 5
    s_add_u32 s38, s38, s80
    s_lshl_b32 s35, s27, 10
    s_add_u32 s38, s38, s35
    s_lshl_b32 s38, s38, 10
    s_lshl_b32 s35, s81, 7
    s_add_u32 s38, s38, s35
    s_add_u32 s38, s38, 64
    v_lshlrev_b32 v21, 5, v18
    v_lshl_add_u32 v21, v19, 4, v21
    v_lshl_add_u32 v15, v17, 16, v21
    v_lshlrev_b32 v21, 4, v17
    v_lshl_add_u32 v14, v16, 9, v21
    s_lshl_b32 s35, s27, 8
    v_add_u32 v14, s35, v14
    v_xor_b32 v68, 0x100, v14
    s_mov_b32 s36, 0xffff0000
    s_mov_b32 s34, 0xbfb8aa3b
    s_lshl_b32 s35, s20, 11
    s_add_u32 s35, s35, 53248
    v_lshl_add_u32 v25, v1, 4, s35
    s_xor_b32 s35, s20, 1
    s_lshl_b32 s35, s35, 11
    s_add_u32 s35, s35, 53248
    v_lshl_add_u32 v24, v1, 4, s35
    v_add_u32 v69, -8192, v25
    v_add_u32 v70, -8192, v24
    s_lshl_b32 s35, s23, 11
    s_add_u32 s35, s35, 156672
    v_lshl_add_u32 v23, v1, 3, s35
    v_and_b32 v21, 7, v1
    v_xor_b32 v20, v19, v21
    v_xor_b32 v20, 4, v20
    v_lshlrev_b32 v20, 4, v20
    v_lshl_add_u32 v20, v18, 3, v20
    v_lshl_add_u32 v20, v17, 7, v20
    s_mul_i32 s40, s69, 151552
    s_lshl_b32 s35, s27, 11
    s_add_u32 s40, s40, s35
    v_add_u32 v18, s40, v20
    v_xor_b32 v19, 32, v18
    s_lshl_b32 s26, s69, 5
    s_add_u32 s26, s26, s80
    s_mul_i32 s26, s26, 88064
    s_lshl_b32 s35, s27, 11
    s_add_u32 s26, s26, s35
    s_add_u32 s26, s26, 8192
    s_add_u32 s30, s26, 81920
    s_cmp_eq_u32 s27, 1
    s_cselect_b32 s30, 0x40000000, s30
    s_mov_b32 s56, s76
    s_mov_b32 s57, s77
    s_mov_b32 s58, 0x200000
    s_mov_b32 s59, 0x20000
    s_cmp_lg_u32 s20, 5
    s_cbranch_scc1 L_p2c_go
    s_lshr_b32 s39, s80, 1
    s_lshl_b32 s39, s39, 11
    s_add_u32 s39, s39, 8388608
    v_lshrrev_b32 v22, 2, v1
    v_lshlrev_b32 v21, 7, v22
    s_mov_b32 s99, 0x40000
Lpoll_h:
    s_sleep 1
    buffer_load_dword v28, v21, s[52:55], s39 offen sc1
    s_waitcnt vmcnt(0)
    v_cmp_ne_u32 vcc, s41, v28
    s_sub_u32 s99, s99, 1
    s_nop 2
    s_cmp_eq_u64 vcc, 0
    s_cselect_b32 s98, 0, s99
    s_cmp_lg_u32 s98, 0
    s_cbranch_scc1 Lpoll_h
L_p2c_go:
    s_mov_b64 s[60:61], 0
    v_mov_b32 v22, 0
    s_waitcnt lgkmcnt(0)
    s_setprio 1
    s_barrier
    s_add_u32 s35, s26, 0
    buffer_load_dwordx4 v[72:75], v14, s[52:55], s35 offen sc1
    buffer_load_dwordx4 v[76:79], v68, s[52:55], s35 offen sc1
    s_add_u32 s35, s26, 8192
    buffer_load_dwordx4 v[80:83], v14, s[52:55], s35 offen sc1
    buffer_load_dwordx4 v[84:87], v68, s[52:55], s35 offen sc1
    s_add_u32 s35, s26, 16384
    buffer_load_dwordx4 v[88:91], v14, s[52:55], s35 offen sc1
    buffer_load_dwordx4 v[92:95], v68, s[52:55], s35 offen sc1
    s_waitcnt vmcnt(4)
    v_mfma_f32_16x16x32_bf16 v[28:31], v[120:123], v[72:75], 0
    s_add_u32 s35, s26, 24576
    v_mfma_f32_16x16x32_bf16 v[32:35], v[124:127], v[72:75], 0
    v_mfma_f32_16x16x32_bf16 v[36:39], v[128:131], v[72:75], 0
    buffer_load_dwordx4 v[96:99], v14, s[52:55], s35 offen sc1
    v_mfma_f32_16x16x32_bf16 v[40:43], v[132:135], v[72:75], 0
    v_mfma_f32_16x16x32_bf16 v[44:47], v[120:123], v[76:79], 0
    v_mfma_f32_16x16x32_bf16 v[48:51], v[124:127], v[76:79], 0
    buffer_load_dwordx4 v[100:103], v68, s[52:55], s35 offen sc1
    v_mfma_f32_16x16x32_bf16 v[52:55], v[128:131], v[76:79], 0
    v_mfma_f32_16x16x32_bf16 v[56:59], v[132:135], v[76:79], 0
    s_setprio 0
    s_barrier
L_p2_main:
    s_waitcnt vmcnt(4)
    v_mfma_f32_16x16x32_bf16 v[28:31], v[136:139], v[80:83], v[28:31]
    s_add_u32 s35, s26, 32768
    buffer_load_dwordx4 v[104:107], v14, s[52:55], s35 offen sc1
    v_mfma_f32_16x16x32_bf16 v[32:35], v[140:143], v[80:83], v[32:35]
    buffer_load_dwordx4 v[108:111], v68, s[52:55], s35 offen sc1
    v_mfma_f32_16x16x32_bf16 v[36:39], v[144:147], v[80:83], v[36:39]
    ds_read_b64_tr_b16 v[120:121], v10 offset:4096
    ds_read_b64_tr_b16 v[122:123], v10 offset:4608
    v_mfma_f32_16x16x32_bf16 v[40:43], v[148:151], v[80:83], v[40:43]
    ds_read_b64_tr_b16 v[124:125], v11 offset:4096
    v_mfma_f32_16x16x32_bf16 v[44:47], v[136:139], v[84:87], v[44:47]
    ds_read_b64_tr_b16 v[126:127], v11 offset:4608
    v_mfma_f32_16x16x32_bf16 v[48:51], v[140:143], v[84:87], v[48:51]
    ds_read_b64_tr_b16 v[128:129], v12 offset:4096
    ds_read_b64_tr_b16 v[130:131], v12 offset:4608
    v_mfma_f32_16x16x32_bf16 v[52:55], v[144:147], v[84:87], v[52:55]
    ds_read_b64_tr_b16 v[132:133], v13 offset:4096
    v_mfma_f32_16x16x32_bf16 v[56:59], v[148:151], v[84:87], v[56:59]
    ds_read_b64_tr_b16 v[134:135], v13 offset:4608
    s_waitcnt vmcnt(4)
    v_mfma_f32_16x16x32_bf16 v[28:31], v[152:155], v[88:91], v[28:31]
    s_add_u32 s35, s26, 40960
    buffer_load_dwordx4 v[112:115], v14, s[52:55], s35 offen sc1
    v_mfma_f32_16x16x32_bf16 v[32:35], v[156:159], v[88:91], v[32:35]
    buffer_load_dwordx4 v[116:119], v68, s[52:55], s35 offen sc1
    v_mfma_f32_16x16x32_bf16 v[36:39], v[160:163], v[88:91], v[36:39]
    ds_read_b64_tr_b16 v[136:137], v10 offset:20480
    ds_read_b64_tr_b16 v[138:139], v10 offset:20992
    v_mfma_f32_16x16x32_bf16 v[40:43], v[164:167], v[88:91], v[40:43]
    ds_read_b64_tr_b16 v[140:141], v11 offset:20480
    v_mfma_f32_16x16x32_bf16 v[44:47], v[152:155], v[92:95], v[44:47]
    ds_read_b64_tr_b16 v[142:143], v11 offset:20992
    v_mfma_f32_16x16x32_bf16 v[48:51], v[156:159], v[92:95], v[48:51]
    ds_read_b64_tr_b16 v[144:145], v12 offset:20480
    ds_read_b64_tr_b16 v[146:147], v12 offset:20992
    v_mfma_f32_16x16x32_bf16 v[52:55], v[160:163], v[92:95], v[52:55]
    ds_read_b64_tr_b16 v[148:149], v13 offset:20480
    v_mfma_f32_16x16x32_bf16 v[56:59], v[164:167], v[92:95], v[56:59]
    ds_read_b64_tr_b16 v[150:151], v13 offset:20992
    s_waitcnt vmcnt(4)
    v_mfma_f32_16x16x32_bf16 v[28:31], v[168:171], v[96:99], v[28:31]
    s_add_u32 s35, s26, 49152
    buffer_load_dwordx4 v[72:75], v14, s[52:55], s35 offen sc1
    v_mfma_f32_16x16x32_bf16 v[32:35], v[172:175], v[96:99], v[32:35]
    buffer_load_dwordx4 v[76:79], v68, s[52:55], s35 offen sc1
    ds_read_b64 v[64:65], v18
    v_mfma_f32_16x16x32_bf16 v[36:39], v[176:179], v[96:99], v[36:39]
    ds_read_b64 v[66:67], v19
    v_mfma_f32_16x16x32_bf16 v[40:43], v[180:183], v[96:99], v[40:43]
    ds_read_b64_tr_b16 v[152:153], v10 offset:36864
    ds_read_b64_tr_b16 v[154:155], v10 offset:37376
    v_mfma_f32_16x16x32_bf16 v[44:47], v[168:171], v[100:103], v[44:47]
    ds_read_b64_tr_b16 v[156:157], v11 offset:36864
    ds_read_b64_tr_b16 v[158:159], v11 offset:37376
    v_mfma_f32_16x16x32_bf16 v[48:51], v[172:175], v[100:103], v[48:51]
    ds_read_b64_tr_b16 v[160:161], v12 offset:36864
    v_mfma_f32_16x16x32_bf16 v[52:55], v[176:179], v[100:103], v[52:55]
    ds_read_b64_tr_b16 v[162:163], v12 offset:37376
    ds_read_b64_tr_b16 v[164:165], v13 offset:36864
    v_mfma_f32_16x16x32_bf16 v[56:59], v[180:183], v[100:103], v[56:59]
    ds_read_b64_tr_b16 v[166:167], v13 offset:37376
    s_waitcnt vmcnt(4) lgkmcnt(8)
    v_mfma_f32_16x16x32_bf16 v[28:31], v[184:187], v[104:107], v[28:31]
    s_add_u32 s35, s26, 57344
    buffer_load_dwordx4 v[80:83], v14, s[52:55], s35 offen sc1
    buffer_load_dwordx4 v[84:87], v68, s[52:55], s35 offen sc1
    v_mfma_f32_16x16x32_bf16 v[32:35], v[188:191], v[104:107], v[32:35]
    v_lshlrev_b32 v216, 16, v64
    v_and_b32 v217, s36, v64
    v_mfma_f32_16x16x32_bf16 v[36:39], v[192:195], v[104:107], v[36:39]
    v_lshlrev_b32 v218, 16, v65
    v_and_b32 v219, s36, v65
    v_lshlrev_b32 v220, 16, v66
    v_mfma_f32_16x16x32_bf16 v[40:43], v[196:199], v[104:107], v[40:43]
    v_and_b32 v221, s36, v66
    v_lshlrev_b32 v222, 16, v67
    v_mfma_f32_16x16x32_bf16 v[44:47], v[184:187], v[108:111], v[44:47]
    v_and_b32 v223, s36, v67
    ds_read_b64_tr_b16 v[168:169], v2 offset:4096
    v_mfma_f32_16x16x32_bf16 v[48:51], v[188:191], v[108:111], v[48:51]
    ds_read_b64_tr_b16 v[170:171], v2 offset:4608
    ds_read_b64_tr_b16 v[172:173], v3 offset:4096
    ds_read_b64_tr_b16 v[174:175], v3 offset:4608
    v_mfma_f32_16x16x32_bf16 v[52:55], v[192:195], v[108:111], v[52:55]
    ds_read_b64_tr_b16 v[176:177], v4 offset:4096
    ds_read_b64_tr_b16 v[178:179], v4 offset:4608
    v_mfma_f32_16x16x32_bf16 v[56:59], v[196:199], v[108:111], v[56:59]
    ds_read_b64_tr_b16 v[180:181], v5 offset:4096
    ds_read_b64_tr_b16 v[182:183], v5 offset:4608
    s_waitcnt vmcnt(4)
    v_mfma_f32_16x16x32_bf16 v[28:31], v[200:203], v[112:115], v[28:31]
    s_add_u32 s35, s26, 65536
    buffer_load_dwordx4 v[88:91], v14, s[52:55], s35 offen sc1
    v_mfma_f32_16x16x32_bf16 v[32:35], v[204:207], v[112:115], v[32:35]
    buffer_load_dwordx4 v[92:95], v68, s[52:55], s35 offen sc1
    v_mfma_f32_16x16x32_bf16 v[36:39], v[208:211], v[112:115], v[36:39]
    ds_read_b64_tr_b16 v[184:185], v2 offset:20480
    ds_read_b64_tr_b16 v[186:187], v2 offset:20992
    v_mfma_f32_16x16x32_bf16 v[40:43], v[212:215], v[112:115], v[40:43]
    ds_read_b64_tr_b16 v[188:189], v3 offset:20480
    v_mfma_f32_16x16x32_bf16 v[44:47], v[200:203], v[116:119], v[44:47]
    ds_read_b64_tr_b16 v[190:191], v3 offset:20992
    v_mfma_f32_16x16x32_bf16 v[48:51], v[204:207], v[116:119], v[48:51]
    ds_read_b64_tr_b16 v[192:193], v4 offset:20480
    ds_read_b64_tr_b16 v[194:195], v4 offset:20992
    v_mfma_f32_16x16x32_bf16 v[52:55], v[208:211], v[116:119], v[52:55]
    ds_read_b64_tr_b16 v[196:197], v5 offset:20480
    v_mfma_f32_16x16x32_bf16 v[56:59], v[212:215], v[116:119], v[56:59]
    ds_read_b64_tr_b16 v[198:199], v5 offset:20992
    s_waitcnt vmcnt(4) lgkmcnt(15)
    v_mfma_f32_16x16x32_bf16 v[28:31], v[120:123], v[72:75], v[28:31]
    s_add_u32 s35, s26, 73728
    v_mfma_f32_16x16x32_bf16 v[32:35], v[124:127], v[72:75], v[32:35]
    v_mfma_f32_16x16x32_bf16 v[36:39], v[128:131], v[72:75], v[36:39]
    buffer_load_dwordx4 v[96:99], v14, s[52:55], s35 offen sc1
    v_mfma_f32_16x16x32_bf16 v[40:43], v[132:135], v[72:75], v[40:43]
    v_mfma_f32_16x16x32_bf16 v[44:47], v[120:123], v[76:79], v[44:47]
    v_mfma_f32_16x16x32_bf16 v[48:51], v[124:127], v[76:79], v[48:51]
    buffer_load_dwordx4 v[100:103], v68, s[52:55], s35 offen sc1
    v_mfma_f32_16x16x32_bf16 v[52:55], v[128:131], v[76:79], v[52:55]
    v_mfma_f32_16x16x32_bf16 v[56:59], v[132:135], v[76:79], v[56:59]
    s_waitcnt vmcnt(4) lgkmcnt(15)
    v_mfma_f32_16x16x32_bf16 v[28:31], v[136:139], v[80:83], v[28:31]
    buffer_load_dwordx4 v[104:107], v14, s[52:55], s30 offen sc1
    v_mfma_f32_16x16x32_bf16 v[32:35], v[140:143], v[80:83], v[32:35]
    v_mfma_f32_16x16x32_bf16 v[36:39], v[144:147], v[80:83], v[36:39]
    v_mfma_f32_16x16x32_bf16 v[40:43], v[148:151], v[80:83], v[40:43]
    v_mfma_f32_16x16x32_bf16 v[44:47], v[136:139], v[84:87], v[44:47]
    buffer_load_dwordx4 v[108:111], v68, s[52:55], s30 offen sc1
    v_mfma_f32_16x16x32_bf16 v[48:51], v[140:143], v[84:87], v[48:51]
    v_mfma_f32_16x16x32_bf16 v[52:55], v[144:147], v[84:87], v[52:55]
    v_mfma_f32_16x16x32_bf16 v[56:59], v[148:151], v[84:87], v[56:59]
    s_waitcnt vmcnt(4) lgkmcnt(15)
    v_mfma_f32_16x16x32_bf16 v[28:31], v[152:155], v[88:91], v[28:31]
    v_mfma_f32_16x16x32_bf16 v[32:35], v[156:159], v[88:91], v[32:35]
    v_mfma_f32_16x16x32_bf16 v[36:39], v[160:163], v[88:91], v[36:39]
    v_mfma_f32_16x16x32_bf16 v[40:43], v[164:167], v[88:91], v[40:43]
    v_mfma_f32_16x16x32_bf16 v[44:47], v[152:155], v[92:95], v[44:47]
    v_mfma_f32_16x16x32_bf16 v[48:51], v[156:159], v[92:95], v[48:51]
    v_mfma_f32_16x16x32_bf16 v[52:55], v[160:163], v[92:95], v[52:55]
    v_mfma_f32_16x16x32_bf16 v[56:59], v[164:167], v[92:95], v[56:59]
    s_waitcnt vmcnt(2) lgkmcnt(8)
    v_mfma_f32_16x16x32_bf16 v[28:31], v[168:171], v[96:99], v[28:31]
    v_mfma_f32_16x16x32_bf16 v[32:35], v[172:175], v[96:99], v[32:35]
    v_mfma_f32_16x16x32_bf16 v[36:39], v[176:179], v[96:99], v[36:39]
    v_mfma_f32_16x16x32_bf16 v[40:43], v[180:183], v[96:99], v[40:43]
    v_mfma_f32_16x16x32_bf16 v[44:47], v[168:171], v[100:103], v[44:47]
    v_mfma_f32_16x16x32_bf16 v[48:51], v[172:175], v[100:103], v[48:51]
    v_mfma_f32_16x16x32_bf16 v[52:55], v[176:179], v[100:103], v[52:55]
    v_mfma_f32_16x16x32_bf16 v[56:59], v[180:183], v[100:103], v[56:59]
    s_waitcnt vmcnt(0) lgkmcnt(0)
    v_mfma_f32_16x16x32_bf16 v[36:39], v[192:195], v[104:107], v[36:39]
    v_mfma_f32_16x16x32_bf16 v[40:43], v[196:199], v[104:107], v[40:43]
    v_mfma_f32_16x16x32_bf16 v[44:47], v[184:187], v[108:111], v[44:47]
    v_mfma_f32_16x16x32_bf16 v[48:51], v[188:191], v[108:111], v[48:51]
    v_mfma_f32_16x16x32_bf16 v[52:55], v[192:195], v[108:111], v[52:55]
    v_mfma_f32_16x16x32_bf16 v[56:59], v[196:199], v[108:111], v[56:59]
    v_mfma_f32_16x16x32_bf16 v[28:31], v[184:187], v[104:107], v[28:31]
    v_mfma_f32_16x16x32_bf16 v[32:35], v[188:191], v[104:107], v[32:35]
    s_nop 0
    ds_write_b128 v69, v[36:39] offset:16384
    ds_write_b128 v69, v[40:43] offset:17408
    ds_write_b128 v24, v[44:47]
    ds_write_b128 v24, v[48:51] offset:1024
    ds_write_b128 v70, v[52:55] offset:32768
    ds_write_b128 v70, v[56:59] offset:33792
    s_waitcnt lgkmcnt(0)
    s_barrier
    ds_read_b128 v[36:39], v25
    ds_read_b128 v[40:43], v25 offset:1024
    ds_read_b128 v[44:47], v25 offset:16384
    ds_read_b128 v[48:51], v25 offset:17408
    ds_read_b128 v[52:55], v25 offset:32768
    ds_read_b128 v[56:59], v25 offset:33792
    ds_read_b64 v[64:65], v23
    ds_read_b64 v[66:67], v23 offset:512
    s_waitcnt lgkmcnt(6)
    .p2align 3
    v_pk_add_f32 v[28:29], v[28:29], v[36:37]
    v_pk_add_f32 v[30:31], v[30:31], v[38:39]
    v_pk_add_f32 v[32:33], v[32:33], v[40:41]
    v_pk_add_f32 v[34:35], v[34:35], v[42:43]
    s_waitcnt lgkmcnt(2)
    s_nop 0
    v_pk_add_f32 v[44:45], v[44:45], v[52:53]
    v_pk_add_f32 v[46:47], v[46:47], v[54:55]
    v_pk_add_f32 v[48:49], v[48:49], v[56:57]
    v_pk_add_f32 v[50:51], v[50:51], v[58:59]
    v_pk_add_f32 v[28:29], v[28:29], v[44:45]
    v_pk_add_f32 v[30:31], v[30:31], v[46:47]
    v_pk_add_f32 v[32:33], v[32:33], v[48:49]
    v_pk_add_f32 v[34:35], v[34:35], v[50:51]
    v_pk_mul_f32 v[104:105], v[28:29], s[34:35] op_sel_hi:[1,0]
    v_pk_mul_f32 v[106:107], v[30:31], s[34:35] op_sel_hi:[1,0]
    v_pk_mul_f32 v[108:109], v[32:33], s[34:35] op_sel_hi:[1,0]
    v_pk_mul_f32 v[110:111], v[34:35], s[34:35] op_sel_hi:[1,0]
    v_exp_f32 v104, v104
    v_exp_f32 v105, v105
    v_exp_f32 v106, v106
    v_exp_f32 v107, v107
    v_exp_f32 v108, v108
    v_exp_f32 v109, v109
    v_exp_f32 v110, v110
    v_exp_f32 v111, v111
    s_waitcnt lgkmcnt(0)
    s_nop 0
    v_lshlrev_b32 v112, 16, v64
    v_and_b32 v113, s36, v64
    v_lshlrev_b32 v114, 16, v65
    v_and_b32 v115, s36, v65
    v_lshlrev_b32 v116, 16, v66
    v_and_b32 v117, s36, v66
    v_lshlrev_b32 v118, 16, v67
    v_and_b32 v119, s36, v67
    v_pk_mul_f32 v[28:29], v[28:29], v[112:113]
    v_pk_mul_f32 v[30:31], v[30:31], v[114:115]
    v_pk_mul_f32 v[32:33], v[32:33], v[116:117]
    v_pk_mul_f32 v[34:35], v[34:35], v[118:119]
    v_pk_add_f32 v[104:105], v[104:105], 1.0 op_sel_hi:[1,0]
    v_pk_add_f32 v[106:107], v[106:107], 1.0 op_sel_hi:[1,0]
    v_pk_add_f32 v[108:109], v[108:109], 1.0 op_sel_hi:[1,0]
    v_pk_add_f32 v[110:111], v[110:111], 1.0 op_sel_hi:[1,0]
    v_rcp_f32 v104, v104
    v_rcp_f32 v105, v105
    v_rcp_f32 v106, v106
    v_rcp_f32 v107, v107
    v_rcp_f32 v108, v108
    v_rcp_f32 v109, v109
    v_rcp_f32 v110, v110
    v_rcp_f32 v111, v111
    v_pk_fma_f32 v[216:217], v[28:29], v[104:105], v[216:217]
    v_pk_fma_f32 v[218:219], v[30:31], v[106:107], v[218:219]
    v_pk_fma_f32 v[220:221], v[32:33], v[108:109], v[220:221]
    v_pk_fma_f32 v[222:223], v[34:35], v[110:111], v[222:223]
    v_cvt_pk_bf16_f32 v64, v216, v217
    v_cvt_pk_bf16_f32 v66, v220, v221
    v_cvt_pk_bf16_f32 v65, v218, v219
    v_cvt_pk_bf16_f32 v67, v222, v223
    v_permlane16_swap_b32 v64, v66
    s_nop 0
    v_permlane16_swap_b32 v65, v67
    buffer_store_dwordx4 v[64:67], v15, s[56:59], s38 offen sc1
    s_endpgm
L_mix:
    s_setprio 3
    v_lshlrev_b32 v7, 1, v6
    v_xor_b32 v7, v5, v7
    v_lshlrev_b32 v7, 4, v7
    v_lshl_add_u32 v2, v4, 16, v7
    s_and_b32 s37, s20, 1
    s_lshl_b32 s35, s37, 4
    v_xor_b32 v2, s35, v2
    v_xor_b32 v7, v5, v6
    v_lshlrev_b32 v7, 4, v7
    v_lshl_add_u32 v3, v4, 12, v7
    v_xor_b32 v4, 64, v3
    v_add_u32 v4, 31744, v4
    s_lshl_b32 s21, s21, 1
    s_add_u32 s21, s21, s18
    s_lshl_b32 s25, s24, 5
    s_add_u32 s25, s25, s21
    s_lshl_b32 s26, s23, 9
    s_add_u32 s25, s25, s26
    s_lshl_b32 s25, s25, 10
    s_lshl_b32 s26, s20, 10
    s_lshl_b32 s31, s23, 16
    s_xor_b32 s30, s20, 4
    s_lshl_b32 s30, s30, 11
    s_waitcnt lgkmcnt(0)
    s_mov_b32 s44, s4
    s_mov_b32 s45, s5
    s_mov_b32 s46, 0x200000
    s_mov_b32 s47, 0x20000
    s_cmp_eq_u32 s24, 0
    s_cselect_b32 s72, s10, s8
    s_cselect_b32 s73, s11, s9
    s_mov_b32 s74, 0x80000
    s_mov_b32 s75, 0x20000
    s_add_u32 m0, s30, 65536
    s_nop 0
    buffer_load_dwordx4 v3, s[72:75], s31 offen lds
    buffer_load_dwordx4 v4, s[72:75], s31 offen offset:1024 lds
    s_add_u32 m0, s26, 0
    s_nop 0
    buffer_load_dwordx4 v2, s[44:47], s25 offen lds
    s_add_u32 m0, s26, 8064
    s_nop 0
    buffer_load_dwordx4 v2, s[44:47], s25 offen offset:128 lds
    s_setprio 2
    s_add_u32 m0, s26, 16128
    s_nop 0
    buffer_load_dwordx4 v2, s[44:47], s25 offen offset:256 lds
    s_add_u32 m0, s26, 24192
    s_nop 0
    buffer_load_dwordx4 v2, s[44:47], s25 offen offset:384 lds
    s_setprio 0
    s_mov_b32 s52, s16
    s_mov_b32 s53, s17
    s_mov_b32 s54, 0xa00000
    s_mov_b32 s55, 0x20000
    s_mov_b32 s88, s78
    s_mov_b32 s89, s79
    s_mov_b32 s90, 0x100
    s_mov_b32 s91, 0x20000
    s_lshr_b32 s36, s23, 1
    s_cmp_eq_u32 s24, 0
    s_cbranch_scc0 L_dft
    s_mov_b32 s48, s12
    s_mov_b32 s49, s13
    s_mov_b32 s50, 0x158000
    s_mov_b32 s51, 0x20000
    s_mov_b32 s56, s14
    s_mov_b32 s57, s15
    s_mov_b32 s58, 0x158000
    s_mov_b32 s59, 0x20000
    v_lshrrev_b32 v8, 2, v1
    v_and_b32 v9, 3, v1
    v_mul_u32_u24 v8, s28, v8
    v_lshl_add_u32 v5, v9, 4, v8
    v_xor_b32 v9, 2, v9
    v_lshl_add_u32 v6, v9, 4, v8
    s_mul_i32 s29, s23, 44032
    s_add_u32 s29, s29, 2688
    s_lshl_b32 s33, s36, 5
    s_add_u32 s33, s33, s21
    s_mul_i32 s33, s33, 88064
    s_lshl_b32 s35, s37, 10
    s_add_u32 s33, s33, s35
    s_add_u32 s33, s33, 90112
    v_and_b32 v14, 31, v1
    v_lshrrev_b32 v15, 5, v1
    v_and_b32 v10, 6, v1
    v_bfe_u32 v11, v1, 3, 1
    v_or_b32 v10, v10, v11
    v_xor_b32 v10, v10, v15
    v_lshlrev_b32 v10, 4, v10
    v_lshl_add_u32 v12, v14, 7, v10
    s_lshl_b32 s35, s36, 12
    s_lshl_b32 s39, s37, 6
    v_xor_b32 v12, s39, v12
    v_add_u32 v64, s35, v12
    v_xor_b32 v65, 32, v64
    v_xor_b32 v66, 64, v64
    v_xor_b32 v67, 96, v64
    v_bfe_u32 v10, v1, 2, 2
    v_lshl_add_u32 v10, v15, 3, v10
    v_and_b32 v11, 3, v1
    v_lshlrev_b32 v11, 3, v11
    v_lshl_add_u32 v10, v10, 6, v11
    v_bfe_u32 v11, v1, 4, 1
    v_lshl_add_u32 v10, v11, 12, v10
    v_xor_b32 v11, s37, v11
    v_lshl_add_u32 v10, v11, 5, v10
    s_lshl_b32 s35, s37, 11
    s_add_u32 s35, s35, 98304
    v_add_u32 v68, s35, v10
    v_xor_b32 v69, 1024, v68
    v_xor_b32 v70, 2048, v68
    v_xor_b32 v71, 3072, v68
    s_lshl_b32 s35, s36, 10
    v_lshl_add_u32 v72, v14, 5, s35
    s_lshl_b32 s35, s37, 4
    v_lshl_add_u32 v15, v15, 3, s35
    v_add_u32 v73, v15, v72
    v_lshrrev_b32 v8, 2, v1
    v_xor_b32 v8, v8, v1
    v_and_b32 v8, 4, v8
    v_and_b32 v9, 3, v1
    v_or_b32 v8, v8, v9
    v_cmp_eq_u32 vcc, 0, v8
    v_mov_b32 v9, 0x3f803f80
    v_mov_b32 v20, 0
    v_mov_b32 v21, 0
    v_mov_b32 v22, 0
    v_mov_b32 v23, 0
    v_cndmask_b32 v16, 0, v9, vcc
    v_cndmask_b32 v17, 0, v9, vcc
    v_cndmask_b32 v18, 0, v9, vcc
    v_cndmask_b32 v19, 0, v9, vcc
    s_mov_b32 s34, 0xffff0000
    v_lshlrev_b32 v74, 2, v14
    v_add_u32 v74, 73728, v74
    v_mov_b32 v75, 0xbf803f80
    s_add_u32 m0, s30, 81792
    s_nop 0
    buffer_load_dwordx4 v3, s[72:75], s31 offen offset:128 lds
    buffer_load_dwordx4 v4, s[72:75], s31 offen offset:1152 lds
    s_add_u32 m0, s26, 32256
    s_nop 0
    buffer_load_dwordx4 v2, s[44:47], s25 offen offset:512 lds
    s_add_u32 m0, s26, 40320
    s_nop 0
    buffer_load_dwordx4 v2, s[44:47], s25 offen offset:640 lds
    s_add_u32 m0, s26, 48384
    s_nop 0
    buffer_load_dwordx4 v2, s[44:47], s25 offen offset:768 lds
    s_add_u32 m0, s26, 56448
    s_nop 0
    buffer_load_dwordx4 v2, s[44:47], s25 offen offset:896 lds
    s_waitcnt vmcnt(8)
    s_cmp_eq_u32 s20, 0
    s_cselect_b64 exec, -1, 0
    ds_write_b32 v74, v75
    s_mov_b64 exec, -1
    s_waitcnt lgkmcnt(0)
    s_barrier
    ds_read_b128 v[96:99], v64
    ds_read_b128 v[100:103], v65
    ds_read_b128 v[112:115], v64 offset:8192
    ds_read_b128 v[116:119], v65 offset:8192
    ds_read_b128 v[104:107], v66
    ds_read_b128 v[108:111], v67
    ds_read_b128 v[120:123], v66 offset:8192
    ds_read_b128 v[124:127], v67 offset:8192
    s_waitcnt lgkmcnt(4)
    v_lshlrev_b32 v8, 16, v96
    s_add_u32 m0, s26, 98304
    s_nop 0
    buffer_load_dwordx4 v5, s[48:51], s29 offen lds
    v_and_b32 v9, s34, v96
    v_lshlrev_b32 v10, 16, v97
    v_and_b32 v11, s34, v97
    v_add_f32 v20, v20, v8
    v_add_f32 v21, v21, v9
    v_fmac_f32 v22, v8, v8
    v_fmac_f32 v23, v9, v9
    v_add_f32 v20, v20, v10
    v_add_f32 v21, v21, v11
    v_fmac_f32 v22, v10, v10
    v_fmac_f32 v23, v11, v11
    v_lshlrev_b32 v8, 16, v98
    v_and_b32 v9, s34, v98
    v_lshlrev_b32 v10, 16, v99
    v_and_b32 v11, s34, v99
    v_add_f32 v20, v20, v8
    v_add_f32 v21, v21, v9
    v_fmac_f32 v22, v8, v8
    v_fmac_f32 v23, v9, v9
    v_add_f32 v20, v20, v10
    v_add_f32 v21, v21, v11
    v_fmac_f32 v22, v10, v10
    v_fmac_f32 v23, v11, v11
    v_lshlrev_b32 v8, 16, v100
    s_add_u32 m0, s26, 102400
    s_nop 0
    buffer_load_dwordx4 v6, s[56:59], s29 offen lds
    s_add_u32 s29, s29, 176128
    v_and_b32 v9, s34, v100
    v_lshlrev_b32 v10, 16, v101
    v_and_b32 v11, s34, v101
    v_add_f32 v20, v20, v8
    v_add_f32 v21, v21, v9
    v_fmac_f32 v22, v8, v8
    v_fmac_f32 v23, v9, v9
    v_add_f32 v20, v20, v10
    v_add_f32 v21, v21, v11
    v_fmac_f32 v22, v10, v10
    v_fmac_f32 v23, v11, v11
    v_lshlrev_b32 v8, 16, v102
    v_and_b32 v9, s34, v102
    v_lshlrev_b32 v10, 16, v103
    v_and_b32 v11, s34, v103
    v_add_f32 v20, v20, v8
    v_add_f32 v21, v21, v9
    v_fmac_f32 v22, v8, v8
    v_fmac_f32 v23, v9, v9
    v_add_f32 v20, v20, v10
    v_add_f32 v21, v21, v11
    v_fmac_f32 v22, v10, v10
    v_fmac_f32 v23, v11, v11
    v_lshlrev_b32 v8, 16, v112
    s_add_u32 m0, s26, 106496
    s_nop 0
    buffer_load_dwordx4 v5, s[48:51], s29 offen lds
    v_and_b32 v9, s34, v112
    v_lshlrev_b32 v10, 16, v113
    v_and_b32 v11, s34, v113
    v_add_f32 v20, v20, v8
    v_add_f32 v21, v21, v9
    v_fmac_f32 v22, v8, v8
    v_fmac_f32 v23, v9, v9
    v_add_f32 v20, v20, v10
    v_add_f32 v21, v21, v11
    v_fmac_f32 v22, v10, v10
    v_fmac_f32 v23, v11, v11
    v_lshlrev_b32 v8, 16, v114
    v_and_b32 v9, s34, v114
    v_lshlrev_b32 v10, 16, v115
    v_and_b32 v11, s34, v115
    v_add_f32 v20, v20, v8
    v_add_f32 v21, v21, v9
    v_fmac_f32 v22, v8, v8
    v_fmac_f32 v23, v9, v9
    v_add_f32 v20, v20, v10
    v_add_f32 v21, v21, v11
    v_fmac_f32 v22, v10, v10
    v_fmac_f32 v23, v11, v11
    v_lshlrev_b32 v8, 16, v116
    s_add_u32 m0, s26, 110592
    s_nop 0
    buffer_load_dwordx4 v6, s[56:59], s29 offen lds
    s_add_u32 s29, s29, 176128
    v_and_b32 v9, s34, v116
    v_lshlrev_b32 v10, 16, v117
    v_and_b32 v11, s34, v117
    v_add_f32 v20, v20, v8
    v_add_f32 v21, v21, v9
    v_fmac_f32 v22, v8, v8
    v_fmac_f32 v23, v9, v9
    v_add_f32 v20, v20, v10
    v_add_f32 v21, v21, v11
    v_fmac_f32 v22, v10, v10
    v_fmac_f32 v23, v11, v11
    v_lshlrev_b32 v8, 16, v118
    v_and_b32 v9, s34, v118
    v_lshlrev_b32 v10, 16, v119
    v_and_b32 v11, s34, v119
    v_add_f32 v20, v20, v8
    v_add_f32 v21, v21, v9
    v_fmac_f32 v22, v8, v8
    v_fmac_f32 v23, v9, v9
    v_add_f32 v20, v20, v10
    v_add_f32 v21, v21, v11
    v_fmac_f32 v22, v10, v10
    v_fmac_f32 v23, v11, v11
    s_waitcnt vmcnt(10)
    s_waitcnt lgkmcnt(0)
    s_barrier
    ds_read_b128 v[128:131], v64 offset:16384
    ds_read_b128 v[132:135], v65 offset:16384
    ds_read_b128 v[144:147], v64 offset:24576
    ds_read_b128 v[148:151], v65 offset:24576
    ds_read_b128 v[136:139], v66 offset:16384
    ds_read_b128 v[140:143], v67 offset:16384
    ds_read_b128 v[152:155], v66 offset:24576
    ds_read_b128 v[156:159], v67 offset:24576
    s_waitcnt lgkmcnt(4)
    v_lshlrev_b32 v8, 16, v128
    s_add_u32 m0, s26, 114688
    s_nop 0
    buffer_load_dwordx4 v5, s[48:51], s29 offen lds
    v_and_b32 v9, s34, v128
    v_lshlrev_b32 v10, 16, v129
    v_and_b32 v11, s34, v129
    v_add_f32 v20, v20, v8
    v_add_f32 v21, v21, v9
    v_fmac_f32 v22, v8, v8
    v_fmac_f32 v23, v9, v9
    v_add_f32 v20, v20, v10
    v_add_f32 v21, v21, v11
    v_fmac_f32 v22, v10, v10
    v_fmac_f32 v23, v11, v11
    v_lshlrev_b32 v8, 16, v130
    v_and_b32 v9, s34, v130
    v_lshlrev_b32 v10, 16, v131
    v_and_b32 v11, s34, v131
    v_add_f32 v20, v20, v8
    v_add_f32 v21, v21, v9
    v_fmac_f32 v22, v8, v8
    v_fmac_f32 v23, v9, v9
    v_add_f32 v20, v20, v10
    v_add_f32 v21, v21, v11
    v_fmac_f32 v22, v10, v10
    v_fmac_f32 v23, v11, v11
    v_lshlrev_b32 v8, 16, v132
    s_add_u32 m0, s26, 118784
    s_nop 0
    buffer_load_dwordx4 v6, s[56:59], s29 offen lds
    s_add_u32 s29, s29, 176128
    v_and_b32 v9, s34, v132
    v_lshlrev_b32 v10, 16, v133
    v_and_b32 v11, s34, v133
    v_add_f32 v20, v20, v8
    v_add_f32 v21, v21, v9
    v_fmac_f32 v22, v8, v8
    v_fmac_f32 v23, v9, v9
    v_add_f32 v20, v20, v10
    v_add_f32 v21, v21, v11
    v_fmac_f32 v22, v10, v10
    v_fmac_f32 v23, v11, v11
    v_lshlrev_b32 v8, 16, v134
    v_and_b32 v9, s34, v134
    v_lshlrev_b32 v10, 16, v135
    v_and_b32 v11, s34, v135
    v_add_f32 v20, v20, v8
    v_add_f32 v21, v21, v9
    v_fmac_f32 v22, v8, v8
    v_fmac_f32 v23, v9, v9
    v_add_f32 v20, v20, v10
    v_add_f32 v21, v21, v11
    v_fmac_f32 v22, v10, v10
    v_fmac_f32 v23, v11, v11
    v_lshlrev_b32 v8, 16, v144
    s_add_u32 m0, s26, 122880
    s_nop 0
    buffer_load_dwordx4 v5, s[48:51], s29 offen lds
    v_and_b32 v9, s34, v144
    v_lshlrev_b32 v10, 16, v145
    v_and_b32 v11, s34, v145
    v_add_f32 v20, v20, v8
    v_add_f32 v21, v21, v9
    v_fmac_f32 v22, v8, v8
    v_fmac_f32 v23, v9, v9
    v_add_f32 v20, v20, v10
    v_add_f32 v21, v21, v11
    v_fmac_f32 v22, v10, v10
    v_fmac_f32 v23, v11, v11
    v_lshlrev_b32 v8, 16, v146
    v_and_b32 v9, s34, v146
    v_lshlrev_b32 v10, 16, v147
    v_and_b32 v11, s34, v147
    v_add_f32 v20, v20, v8
    v_add_f32 v21, v21, v9
    v_fmac_f32 v22, v8, v8
    v_fmac_f32 v23, v9, v9
    v_add_f32 v20, v20, v10
    v_add_f32 v21, v21, v11
    v_fmac_f32 v22, v10, v10
    v_fmac_f32 v23, v11, v11
    v_lshlrev_b32 v8, 16, v148
    s_add_u32 m0, s26, 126976
    s_nop 0
    buffer_load_dwordx4 v6, s[56:59], s29 offen lds
    s_add_u32 s29, s29, 176128
    v_and_b32 v9, s34, v148
    v_lshlrev_b32 v10, 16, v149
    v_and_b32 v11, s34, v149
    v_add_f32 v20, v20, v8
    v_add_f32 v21, v21, v9
    v_fmac_f32 v22, v8, v8
    v_fmac_f32 v23, v9, v9
    v_add_f32 v20, v20, v10
    v_add_f32 v21, v21, v11
    v_fmac_f32 v22, v10, v10
    v_fmac_f32 v23, v11, v11
    v_lshlrev_b32 v8, 16, v150
    v_and_b32 v9, s34, v150
    v_lshlrev_b32 v10, 16, v151
    v_and_b32 v11, s34, v151
    v_add_f32 v20, v20, v8
    v_add_f32 v21, v21, v9
    v_fmac_f32 v22, v8, v8
    v_fmac_f32 v23, v9, v9
    v_add_f32 v20, v20, v10
    v_add_f32 v21, v21, v11
    v_fmac_f32 v22, v10, v10
    v_fmac_f32 v23, v11, v11
    s_waitcnt vmcnt(10)
    s_cmp_eq_u32 s20, 0
    s_cselect_b64 exec, -1, 0
    ds_write_b32 v74, v75 offset:16384
    s_mov_b64 exec, -1
    s_waitcnt lgkmcnt(0)
    s_barrier
    ds_read_b128 v[160:163], v64 offset:32768
    ds_read_b128 v[164:167], v65 offset:32768
    ds_read_b128 v[176:179], v64 offset:40960
    ds_read_b128 v[180:183], v65 offset:40960
    ds_read_b128 v[168:171], v66 offset:32768
    ds_read_b128 v[172:175], v67 offset:32768
    ds_read_b128 v[184:187], v66 offset:40960
    ds_read_b128 v[188:191], v67 offset:40960
    s_waitcnt lgkmcnt(4)
    buffer_load_dword v79, off, s[88:91], 0
    v_lshlrev_b32 v8, 16, v160
    s_add_u32 m0, s26, 131072
    s_nop 0
    buffer_load_dwordx4 v5, s[48:51], s29 offen lds
    v_and_b32 v9, s34, v160
    v_lshlrev_b32 v10, 16, v161
    v_and_b32 v11, s34, v161
    v_add_f32 v20, v20, v8
    v_add_f32 v21, v21, v9
    v_fmac_f32 v22, v8, v8
    v_fmac_f32 v23, v9, v9
    v_add_f32 v20, v20, v10
    v_add_f32 v21, v21, v11
    v_fmac_f32 v22, v10, v10
    v_fmac_f32 v23, v11, v11
    v_lshlrev_b32 v8, 16, v162
    v_and_b32 v9, s34, v162
    v_lshlrev_b32 v10, 16, v163
    v_and_b32 v11, s34, v163
    v_add_f32 v20, v20, v8
    v_add_f32 v21, v21, v9
    v_fmac_f32 v22, v8, v8
    v_fmac_f32 v23, v9, v9
    v_add_f32 v20, v20, v10
    v_add_f32 v21, v21, v11
    v_fmac_f32 v22, v10, v10
    v_fmac_f32 v23, v11, v11
    v_lshlrev_b32 v8, 16, v164
    s_add_u32 m0, s26, 135168
    s_nop 0
    buffer_load_dwordx4 v6, s[56:59], s29 offen lds
    s_add_u32 s29, s29, 176128
    v_and_b32 v9, s34, v164
    v_lshlrev_b32 v10, 16, v165
    v_and_b32 v11, s34, v165
    v_add_f32 v20, v20, v8
    v_add_f32 v21, v21, v9
    v_fmac_f32 v22, v8, v8
    v_fmac_f32 v23, v9, v9
    v_add_f32 v20, v20, v10
    v_add_f32 v21, v21, v11
    v_fmac_f32 v22, v10, v10
    v_fmac_f32 v23, v11, v11
    v_lshlrev_b32 v8, 16, v166
    v_and_b32 v9, s34, v166
    v_lshlrev_b32 v10, 16, v167
    v_and_b32 v11, s34, v167
    v_add_f32 v20, v20, v8
    v_add_f32 v21, v21, v9
    v_fmac_f32 v22, v8, v8
    v_fmac_f32 v23, v9, v9
    v_add_f32 v20, v20, v10
    v_add_f32 v21, v21, v11
    v_fmac_f32 v22, v10, v10
    v_fmac_f32 v23, v11, v11
    v_lshlrev_b32 v8, 16, v176
    s_add_u32 m0, s26, 139264
    s_nop 0
    buffer_load_dwordx4 v5, s[48:51], s29 offen lds
    v_and_b32 v9, s34, v176
    v_lshlrev_b32 v10, 16, v177
    v_and_b32 v11, s34, v177
    v_add_f32 v20, v20, v8
    v_add_f32 v21, v21, v9
    v_fmac_f32 v22, v8, v8
    v_fmac_f32 v23, v9, v9
    v_add_f32 v20, v20, v10
    v_add_f32 v21, v21, v11
    v_fmac_f32 v22, v10, v10
    v_fmac_f32 v23, v11, v11
    v_lshlrev_b32 v8, 16, v178
    v_and_b32 v9, s34, v178
    v_lshlrev_b32 v10, 16, v179
    v_and_b32 v11, s34, v179
    v_add_f32 v20, v20, v8
    v_add_f32 v21, v21, v9
    v_fmac_f32 v22, v8, v8
    v_fmac_f32 v23, v9, v9
    v_add_f32 v20, v20, v10
    v_add_f32 v21, v21, v11
    v_fmac_f32 v22, v10, v10
    v_fmac_f32 v23, v11, v11
    v_lshlrev_b32 v8, 16, v180
    s_add_u32 m0, s26, 143360
    s_nop 0
    buffer_load_dwordx4 v6, s[56:59], s29 offen lds
    s_add_u32 s29, s29, 176128
    v_and_b32 v9, s34, v180
    v_lshlrev_b32 v10, 16, v181
    v_and_b32 v11, s34, v181
    v_add_f32 v20, v20, v8
    v_add_f32 v21, v21, v9
    v_fmac_f32 v22, v8, v8
    v_fmac_f32 v23, v9, v9
    v_add_f32 v20, v20, v10
    v_add_f32 v21, v21, v11
    v_fmac_f32 v22, v10, v10
    v_fmac_f32 v23, v11, v11
    v_lshlrev_b32 v8, 16, v182
    v_and_b32 v9, s34, v182
    v_lshlrev_b32 v10, 16, v183
    v_and_b32 v11, s34, v183
    v_add_f32 v20, v20, v8
    v_add_f32 v21, v21, v9
    v_fmac_f32 v22, v8, v8
    v_fmac_f32 v23, v9, v9
    v_add_f32 v20, v20, v10
    v_add_f32 v21, v21, v11
    v_fmac_f32 v22, v10, v10
    v_fmac_f32 v23, v11, v11
    s_waitcnt vmcnt(13)
    s_waitcnt lgkmcnt(0)
    s_barrier
    ds_read_b128 v[192:195], v64 offset:49152
    ds_read_b128 v[196:199], v65 offset:49152
    ds_read_b128 v[208:211], v64 offset:57344
    ds_read_b128 v[212:215], v65 offset:57344
    ds_read_b128 v[200:203], v66 offset:49152
    ds_read_b128 v[204:207], v67 offset:49152
    ds_read_b128 v[216:219], v66 offset:57344
    ds_read_b128 v[220:223], v67 offset:57344
    s_waitcnt lgkmcnt(4)
    s_mov_b32 s84, s6
    s_mov_b32 s85, s7
    s_mov_b32 s86, 0x158000
    s_mov_b32 s87, 0x20000
    s_lshl_b32 s62, s21, 2
    s_add_u32 s62, s62, s23
    s_mul_i32 s62, s62, 11008
    v_lshlrev_b32 v52, 6, v1
    v_lshlrev_b32 v8, 16, v192
    s_add_u32 m0, s26, 147456
    s_nop 0
    buffer_load_dwordx4 v5, s[48:51], s29 offen lds
    v_and_b32 v9, s34, v192
    v_lshlrev_b32 v10, 16, v193
    v_and_b32 v11, s34, v193
    v_add_f32 v20, v20, v8
    v_add_f32 v21, v21, v9
    v_fmac_f32 v22, v8, v8
    v_fmac_f32 v23, v9, v9
    v_add_f32 v20, v20, v10
    v_add_f32 v21, v21, v11
    v_fmac_f32 v22, v10, v10
    v_fmac_f32 v23, v11, v11
    v_lshlrev_b32 v8, 16, v194
    v_and_b32 v9, s34, v194
    s_add_u32 m0, s26, 151552
    s_nop 0
    buffer_load_dwordx4 v6, s[56:59], s29 offen lds
    s_add_u32 s29, s29, 176128
    v_lshlrev_b32 v10, 16, v195
    v_and_b32 v11, s34, v195
    v_add_f32 v20, v20, v8
    v_add_f32 v21, v21, v9
    v_fmac_f32 v22, v8, v8
    v_fmac_f32 v23, v9, v9
    v_add_f32 v20, v20, v10
    v_add_f32 v21, v21, v11
    v_fmac_f32 v22, v10, v10
    v_fmac_f32 v23, v11, v11
    v_lshlrev_b32 v8, 16, v196
    v_and_b32 v9, s34, v196
    v_lshlrev_b32 v10, 16, v197
    v_and_b32 v11, s34, v197
    s_add_u32 m0, s26, 155648
    s_nop 0
    buffer_load_dwordx4 v5, s[48:51], s29 offen lds
    v_add_f32 v20, v20, v8
    v_add_f32 v21, v21, v9
    v_fmac_f32 v22, v8, v8
    v_fmac_f32 v23, v9, v9
    v_add_f32 v20, v20, v10
    v_add_f32 v21, v21, v11
    v_fmac_f32 v22, v10, v10
    v_fmac_f32 v23, v11, v11
    v_lshlrev_b32 v8, 16, v198
    v_and_b32 v9, s34, v198
    v_lshlrev_b32 v10, 16, v199
    v_and_b32 v11, s34, v199
    v_add_f32 v20, v20, v8
    v_add_f32 v21, v21, v9
    s_add_u32 m0, s26, 159744
    s_nop 0
    buffer_load_dwordx4 v6, s[56:59], s29 offen lds
    s_add_u32 s29, s29, 176128
    v_fmac_f32 v22, v8, v8
    v_fmac_f32 v23, v9, v9
    v_add_f32 v20, v20, v10
    v_add_f32 v21, v21, v11
    v_fmac_f32 v22, v10, v10
    v_fmac_f32 v23, v11, v11
    v_lshlrev_b32 v8, 16, v208
    v_and_b32 v9, s34, v208
    v_lshlrev_b32 v10, 16, v209
    v_and_b32 v11, s34, v209
    v_add_f32 v20, v20, v8
    v_add_f32 v21, v21, v9
    v_fmac_f32 v22, v8, v8
    buffer_load_dword v54, v52, s[84:87], s62 offen
    s_add_u32 s62, s62, 4096
    v_fmac_f32 v23, v9, v9
    v_add_f32 v20, v20, v10
    v_add_f32 v21, v21, v11
    v_fmac_f32 v22, v10, v10
    v_fmac_f32 v23, v11, v11
    v_lshlrev_b32 v8, 16, v210
    v_and_b32 v9, s34, v210
    v_lshlrev_b32 v10, 16, v211
    v_and_b32 v11, s34, v211
    v_add_f32 v20, v20, v8
    v_add_f32 v21, v21, v9
    v_fmac_f32 v22, v8, v8
    v_fmac_f32 v23, v9, v9
    v_add_f32 v20, v20, v10
    buffer_load_dword v54, v52, s[84:87], s62 offen
    s_add_u32 s62, s62, 4096
    v_add_f32 v21, v21, v11
    v_fmac_f32 v22, v10, v10
    v_fmac_f32 v23, v11, v11
    v_lshlrev_b32 v8, 16, v212
    v_and_b32 v9, s34, v212
    v_lshlrev_b32 v10, 16, v213
    v_and_b32 v11, s34, v213
    v_add_f32 v20, v20, v8
    v_add_f32 v21, v21, v9
    v_fmac_f32 v22, v8, v8
    v_fmac_f32 v23, v9, v9
    v_add_f32 v20, v20, v10
    v_add_f32 v21, v21, v11
    v_fmac_f32 v22, v10, v10
    buffer_load_dword v54, v52, s[84:87], s62 offen
    s_add_u32 s62, s62, 4096
    v_fmac_f32 v23, v11, v11
    v_lshlrev_b32 v8, 16, v214
    v_and_b32 v9, s34, v214
    v_lshlrev_b32 v10, 16, v215
    v_and_b32 v11, s34, v215
    v_add_f32 v20, v20, v8
    v_add_f32 v21, v21, v9
    v_fmac_f32 v22, v8, v8
    v_fmac_f32 v23, v9, v9
    v_add_f32 v20, v20, v10
    v_add_f32 v21, v21, v11
    v_fmac_f32 v22, v10, v10
    v_fmac_f32 v23, v11, v11
    v_add_f32 v20, v20, v21
    v_add_f32 v21, v22, v23
    ds_write_b64 v73, v[20:21]
    s_waitcnt lgkmcnt(0)
    s_barrier
    ds_read_b128 v[36:39], v72
    ds_read_b128 v[40:43], v72 offset:16
    s_waitcnt lgkmcnt(0)
    v_pk_add_f32 v[36:37], v[36:37], v[38:39]
    v_pk_add_f32 v[40:41], v[40:41], v[42:43]
    v_pk_add_f32 v[76:77], v[36:37], v[40:41]
    v_mul_f32 v36, 0xbb000000, v76
    v_mul_f32 v38, 0x3b000000, v77
    v_fma_f32 v38, -v36, v36, v38
    v_max_f32 v38, 0, v38
    v_add_f32 v38, 0x3727c5ac, v38
    s_waitcnt vmcnt(11)
    v_readfirstlane_b32 s41, v79
    s_nop 3
    s_cmp_eq_u32 s41, 0
    s_cbranch_scc1 L_tslow_l
L_tok_l:
    v_mov_b32 v37, v79
    v_mov_b32 v39, v79
    s_lshl_b32 s35, s36, 5
    s_add_u32 s35, s35, s21
    s_lshl_b32 s35, s35, 9
    s_add_u32 s35, s35, 8650752
    s_cmp_eq_u32 s37, 0
    s_cselect_b32 s35, s35, 0x40000000
    v_lshlrev_b32 v40, 4, v1
    s_mov_b64 exec, 0xffffffff
    buffer_store_dwordx4 v[36:39], v40, s[52:55], s35 offen sc1
    s_mov_b64 exec, -1
    v_bfe_u32 v8, v1, 4, 1
    s_and_b32 s35, s23, 1
    v_lshl_add_u32 v8, s35, 1, v8
    v_lshlrev_b32 v8, 1, v8
    v_and_b32 v9, 7, v1
    v_xor_b32 v8, v8, v9
    v_lshlrev_b32 v8, 4, v8
    v_lshrrev_b32 v9, 3, v1
    v_lshl_add_u32 v26, v9, 10, v8
    s_lshl_b32 s83, s23, 13
    s_lshl_b32 s35, s81, 7
    s_add_u32 s83, s83, s35
    s_lshl_b32 s92, s23, 10
    s_mov_b32 s84, s6
    s_mov_b32 s85, s7
    s_mov_b32 s86, 0x158000
    s_mov_b32 s87, 0x20000
    s_add_u32 m0, s92, 4096
    s_add_u32 s35, s83, 0
    buffer_load_dwordx4 v26, s[84:87], s35 offen lds
    s_add_u32 m0, s92, 8192
    s_add_u32 s35, s83, 32768
    buffer_load_dwordx4 v26, s[84:87], s35 offen lds
    s_add_u32 m0, s92, 12288
    s_add_u32 s35, s83, 65536
    buffer_load_dwordx4 v26, s[84:87], s35 offen lds
    s_add_u32 m0, s92, 16384
    s_add_u32 s35, s83, 98304
    buffer_load_dwordx4 v26, s[84:87], s35 offen lds
    s_add_u32 m0, s92, 20480
    s_add_u32 s35, s83, 131072
    buffer_load_dwordx4 v26, s[84:87], s35 offen lds
    s_add_u32 m0, s92, 24576
    s_add_u32 s35, s83, 163840
    buffer_load_dwordx4 v26, s[84:87], s35 offen lds
    s_add_u32 m0, s92, 28672
    s_add_u32 s35, s83, 196608
    buffer_load_dwordx4 v26, s[84:87], s35 offen lds
    s_add_u32 m0, s92, 32768
    s_add_u32 s35, s83, 229376
    buffer_load_dwordx4 v26, s[84:87], s35 offen lds
    s_add_u32 m0, s92, 36864
    s_add_u32 s35, s83, 262144
    buffer_load_dwordx4 v26, s[84:87], s35 offen lds
    s_add_u32 m0, s92, 40960
    s_add_u32 s35, s83, 294912
    buffer_load_dwordx4 v26, s[84:87], s35 offen lds
    s_add_u32 m0, s92, 45056
    s_add_u32 s35, s83, 327680
    buffer_load_dwordx4 v26, s[84:87], s35 offen lds
    s_add_u32 m0, s92, 49152
    s_add_u32 s35, s83, 360448
    buffer_load_dwordx4 v26, s[84:87], s35 offen lds
    s_cmp_ge_u32 s81, 4
    s_mov_b32 s64, 0x3a000000
    s_cselect_b32 s64, 0xba000000, s64
    s_lshr_b32 s35, s23, 1
    s_lshl_b32 s35, s35, 5
    s_add_u32 s35, s35, s80
    v_and_b32 v32, 15, v1
    v_lshl_add_u32 v32, v32, 6, s35
    v_cvt_f32_u32 v32, v32
    v_mul_f32 v32, s64, v32
    s_and_b32 s35, s23, 1
    s_lshl_b32 s35, s35, 5
    v_lshrrev_b32 v33, 4, v1
    v_lshl_add_u32 v33, v33, 2, s35
    v_cvt_f32_u32 v33, v33
    v_mul_f32 v33, v33, v32
    v_fmamk_f32 v34, v32, 0x00000000, v33
    v_fmamk_f32 v35, v32, 0x3f800000, v33
    v_fract_f32 v34, v34
    v_fract_f32 v35, v35
    v_cos_f32 v36, v34
    v_sin_f32 v34, v34
    v_cos_f32 v37, v35
    v_sin_f32 v35, v35
    v_cvt_pk_bf16_f32 v40, v36, v34
    v_cvt_pk_bf16_f32 v41, v37, v35
    v_fmamk_f32 v34, v32, 0x40000000, v33
    v_fmamk_f32 v35, v32, 0x40400000, v33
    v_fract_f32 v34, v34
    v_fract_f32 v35, v35
    v_cos_f32 v36, v34
    v_sin_f32 v34, v34
    v_cos_f32 v37, v35
    v_sin_f32 v35, v35
    v_cvt_pk_bf16_f32 v42, v36, v34
    v_cvt_pk_bf16_f32 v43, v37, v35
    v_fmamk_f32 v34, v32, 0x41800000, v33
    v_fmamk_f32 v35, v32, 0x41880000, v33
    v_fract_f32 v34, v34
    v_fract_f32 v35, v35
    v_cos_f32 v36, v34
    v_sin_f32 v34, v34
    v_cos_f32 v37, v35
    v_sin_f32 v35, v35
    v_cvt_pk_bf16_f32 v44, v36, v34
    v_cvt_pk_bf16_f32 v45, v37, v35
    v_fmamk_f32 v34, v32, 0x41900000, v33
    v_fmamk_f32 v35, v32, 0x41980000, v33
    v_fract_f32 v34, v34
    v_fract_f32 v35, v35
    v_cos_f32 v36, v34
    v_sin_f32 v34, v34
    v_cos_f32 v37, v35
    v_sin_f32 v35, v35
    v_cvt_pk_bf16_f32 v46, v36, v34
    v_cvt_pk_bf16_f32 v47, v37, v35
    s_lshl_b32 s35, s23, 11
    s_add_u32 s35, s35, 90112
    v_lshl_add_u32 v32, v1, 4, s35
    ds_write_b128 v32, v[40:43]
    ds_write_b128 v32, v[44:47] offset:1024
    s_waitcnt vmcnt(16) lgkmcnt(0)
    s_barrier
    v_lshlrev_b32 v24, 4, v1
    v_add_u32 v24, 90112, v24
    ds_read_b128 v[224:227], v24
    ds_read_b128 v[228:231], v24 offset:1024
    ds_read_b128 v[232:235], v24 offset:2048
    ds_read_b128 v[236:239], v24 offset:3072
    ds_read_b128 v[240:243], v24 offset:4096
    ds_read_b128 v[244:247], v24 offset:5120
    ds_read_b128 v[248:251], v24 offset:6144
    ds_read_b128 v[252:255], v24 offset:7168
    ds_read_b64_tr_b16 v[32:33], v68
    ds_read_b64_tr_b16 v[34:35], v68 offset:256
    ds_read_b64_tr_b16 v[36:37], v69
    ds_read_b64_tr_b16 v[38:39], v69 offset:256
    ds_read_b64_tr_b16 v[40:41], v70
    ds_read_b64_tr_b16 v[42:43], v70 offset:256
    ds_read_b64_tr_b16 v[44:45], v71
    ds_read_b64_tr_b16 v[46:47], v71 offset:256
    s_waitcnt lgkmcnt(0)
    v_mfma_f32_32x32x16_bf16 v[80:95], v[32:35], v[96:99], 0
    ds_read_b64_tr_b16 v[48:49], v68 offset:8192
    v_mfma_f32_16x16x32_bf16 v[28:31], v[16:19], v[32:35], 0
    ds_read_b64_tr_b16 v[50:51], v68 offset:8448
    v_mfma_f32_32x32x16_bf16 v[80:95], v[36:39], v[100:103], v[80:95]
    ds_read_b64_tr_b16 v[52:53], v69 offset:8192
    v_mfma_f32_16x16x32_bf16 v[28:31], v[16:19], v[36:39], v[28:31]
    ds_read_b64_tr_b16 v[54:55], v69 offset:8448
    v_mfma_f32_32x32x16_bf16 v[80:95], v[40:43], v[104:107], v[80:95]
    ds_read_b64_tr_b16 v[56:57], v70 offset:8192
    v_mfma_f32_16x16x32_bf16 v[28:31], v[16:19], v[40:43], v[28:31]
    ds_read_b64_tr_b16 v[58:59], v70 offset:8448
    v_mfma_f32_32x32x16_bf16 v[80:95], v[44:47], v[108:111], v[80:95]
    ds_read_b64_tr_b16 v[60:61], v71 offset:8192
    v_mfma_f32_16x16x32_bf16 v[28:31], v[16:19], v[44:47], v[28:31]
    ds_read_b64_tr_b16 v[62:63], v71 offset:8448
    s_waitcnt lgkmcnt(0)
    v_mfma_f32_32x32x16_bf16 v[80:95], v[48:51], v[112:115], v[80:95]
    ds_read_b64_tr_b16 v[32:33], v68 offset:16384
    v_mfma_f32_16x16x32_bf16 v[28:31], v[16:19], v[48:51], v[28:31]
    ds_read_b64_tr_b16 v[34:35], v68 offset:16640
    v_mfma_f32_32x32x16_bf16 v[80:95], v[52:55], v[116:119], v[80:95]
    ds_read_b64_tr_b16 v[36:37], v69 offset:16384
    v_mfma_f32_16x16x32_bf16 v[28:31], v[16:19], v[52:55], v[28:31]
    ds_read_b64_tr_b16 v[38:39], v69 offset:16640
    v_mfma_f32_32x32x16_bf16 v[80:95], v[56:59], v[120:123], v[80:95]
    ds_read_b64_tr_b16 v[40:41], v70 offset:16384
    v_mfma_f32_16x16x32_bf16 v[28:31], v[16:19], v[56:59], v[28:31]
    ds_read_b64_tr_b16 v[42:43], v70 offset:16640
    v_mfma_f32_32x32x16_bf16 v[80:95], v[60:63], v[124:127], v[80:95]
    ds_read_b64_tr_b16 v[44:45], v71 offset:16384
    v_mfma_f32_16x16x32_bf16 v[28:31], v[16:19], v[60:63], v[28:31]
    ds_read_b64_tr_b16 v[46:47], v71 offset:16640
    s_waitcnt lgkmcnt(0)
    v_mfma_f32_32x32x16_bf16 v[80:95], v[32:35], v[128:131], v[80:95]
    ds_read_b64_tr_b16 v[48:49], v68 offset:24576
    v_mfma_f32_16x16x32_bf16 v[28:31], v[16:19], v[32:35], v[28:31]
    ds_read_b64_tr_b16 v[50:51], v68 offset:24832
    v_mfma_f32_32x32x16_bf16 v[80:95], v[36:39], v[132:135], v[80:95]
    ds_read_b64_tr_b16 v[52:53], v69 offset:24576
    v_mfma_f32_16x16x32_bf16 v[28:31], v[16:19], v[36:39], v[28:31]
    ds_read_b64_tr_b16 v[54:55], v69 offset:24832
    v_mfma_f32_32x32x16_bf16 v[80:95], v[40:43], v[136:139], v[80:95]
    ds_read_b64_tr_b16 v[56:57], v70 offset:24576
    v_mfma_f32_16x16x32_bf16 v[28:31], v[16:19], v[40:43], v[28:31]
    ds_read_b64_tr_b16 v[58:59], v70 offset:24832
    v_mfma_f32_32x32x16_bf16 v[80:95], v[44:47], v[140:143], v[80:95]
    ds_read_b64_tr_b16 v[60:61], v71 offset:24576
    v_mfma_f32_16x16x32_bf16 v[28:31], v[16:19], v[44:47], v[28:31]
    ds_read_b64_tr_b16 v[62:63], v71 offset:24832
    s_waitcnt lgkmcnt(0)
    v_mfma_f32_32x32x16_bf16 v[80:95], v[48:51], v[144:147], v[80:95]
    ds_read_b64_tr_b16 v[32:33], v68 offset:32768
    v_mfma_f32_16x16x32_bf16 v[28:31], v[16:19], v[48:51], v[28:31]
    ds_read_b64_tr_b16 v[34:35], v68 offset:33024
    v_mfma_f32_32x32x16_bf16 v[80:95], v[52:55], v[148:151], v[80:95]
    ds_read_b64_tr_b16 v[36:37], v69 offset:32768
    v_mfma_f32_16x16x32_bf16 v[28:31], v[16:19], v[52:55], v[28:31]
    ds_read_b64_tr_b16 v[38:39], v69 offset:33024
    v_mfma_f32_32x32x16_bf16 v[80:95], v[56:59], v[152:155], v[80:95]
    ds_read_b64_tr_b16 v[40:41], v70 offset:32768
    v_mfma_f32_16x16x32_bf16 v[28:31], v[16:19], v[56:59], v[28:31]
    ds_read_b64_tr_b16 v[42:43], v70 offset:33024
    v_mfma_f32_32x32x16_bf16 v[80:95], v[60:63], v[156:159], v[80:95]
    ds_read_b64_tr_b16 v[44:45], v71 offset:32768
    v_mfma_f32_16x16x32_bf16 v[28:31], v[16:19], v[60:63], v[28:31]
    ds_read_b64_tr_b16 v[46:47], v71 offset:33024
    s_waitcnt lgkmcnt(0)
    v_mfma_f32_32x32x16_bf16 v[80:95], v[32:35], v[160:163], v[80:95]
    ds_read_b64_tr_b16 v[48:49], v68 offset:40960
    ds_read_b64_tr_b16 v[50:51], v68 offset:41216
    v_mfma_f32_16x16x32_bf16 v[28:31], v[16:19], v[32:35], v[28:31]
    ds_read_b64_tr_b16 v[52:53], v69 offset:40960
    v_mfma_f32_32x32x16_bf16 v[80:95], v[36:39], v[164:167], v[80:95]
    ds_read_b64_tr_b16 v[54:55], v69 offset:41216
    v_mfma_f32_16x16x32_bf16 v[28:31], v[16:19], v[36:39], v[28:31]
    ds_read_b64_tr_b16 v[56:57], v70 offset:40960
    v_mfma_f32_32x32x16_bf16 v[80:95], v[40:43], v[168:171], v[80:95]
    ds_read_b64_tr_b16 v[58:59], v70 offset:41216
    ds_read_b64_tr_b16 v[60:61], v71 offset:40960
    v_mfma_f32_16x16x32_bf16 v[28:31], v[16:19], v[40:43], v[28:31]
    ds_read_b64_tr_b16 v[62:63], v71 offset:41216
    v_mfma_f32_32x32x16_bf16 v[80:95], v[44:47], v[172:175], v[80:95]
    s_add_u32 m0, s92, 53248
    s_add_u32 s35, s83, 393216
    buffer_load_dwordx4 v26, s[84:87], s35 offen lds
    v_mfma_f32_16x16x32_bf16 v[28:31], v[16:19], v[44:47], v[28:31]
    s_add_u32 m0, s92, 57344
    s_add_u32 s35, s83, 425984
    buffer_load_dwordx4 v26, s[84:87], s35 offen lds
    s_waitcnt lgkmcnt(0)
    v_mfma_f32_32x32x16_bf16 v[80:95], v[48:51], v[176:179], v[80:95]
    ds_read_b64_tr_b16 v[32:33], v68 offset:49152
    ds_read_b64_tr_b16 v[34:35], v68 offset:49408
    v_mfma_f32_16x16x32_bf16 v[28:31], v[16:19], v[48:51], v[28:31]
    ds_read_b64_tr_b16 v[36:37], v69 offset:49152
    v_mfma_f32_32x32x16_bf16 v[80:95], v[52:55], v[180:183], v[80:95]
    ds_read_b64_tr_b16 v[38:39], v69 offset:49408
    v_mfma_f32_16x16x32_bf16 v[28:31], v[16:19], v[52:55], v[28:31]
    ds_read_b64_tr_b16 v[40:41], v70 offset:49152
    v_mfma_f32_32x32x16_bf16 v[80:95], v[56:59], v[184:187], v[80:95]
    ds_read_b64_tr_b16 v[42:43], v70 offset:49408
    ds_read_b64_tr_b16 v[44:45], v71 offset:49152
    v_mfma_f32_16x16x32_bf16 v[28:31], v[16:19], v[56:59], v[28:31]
    ds_read_b64_tr_b16 v[46:47], v71 offset:49408
    v_mfma_f32_32x32x16_bf16 v[80:95], v[60:63], v[188:191], v[80:95]
    s_add_u32 m0, s92, 61440
    s_add_u32 s35, s83, 458752
    buffer_load_dwordx4 v26, s[84:87], s35 offen lds
    v_mfma_f32_16x16x32_bf16 v[28:31], v[16:19], v[60:63], v[28:31]
    s_add_u32 m0, s92, 65536
    s_add_u32 s35, s83, 491520
    buffer_load_dwordx4 v26, s[84:87], s35 offen lds
    s_waitcnt lgkmcnt(0)
    v_mfma_f32_32x32x16_bf16 v[80:95], v[32:35], v[192:195], v[80:95]
    ds_read_b64_tr_b16 v[48:49], v68 offset:57344
    ds_read_b64_tr_b16 v[50:51], v68 offset:57600
    v_mfma_f32_16x16x32_bf16 v[28:31], v[16:19], v[32:35], v[28:31]
    ds_read_b64_tr_b16 v[52:53], v69 offset:57344
    v_mfma_f32_32x32x16_bf16 v[80:95], v[36:39], v[196:199], v[80:95]
    ds_read_b64_tr_b16 v[54:55], v69 offset:57600
    v_mfma_f32_16x16x32_bf16 v[28:31], v[16:19], v[36:39], v[28:31]
    ds_read_b64_tr_b16 v[56:57], v70 offset:57344
    v_mfma_f32_32x32x16_bf16 v[80:95], v[40:43], v[200:203], v[80:95]
    ds_read_b64_tr_b16 v[58:59], v70 offset:57600
    ds_read_b64_tr_b16 v[60:61], v71 offset:57344
    v_mfma_f32_16x16x32_bf16 v[28:31], v[16:19], v[40:43], v[28:31]
    ds_read_b64_tr_b16 v[62:63], v71 offset:57600
    v_mfma_f32_32x32x16_bf16 v[80:95], v[44:47], v[204:207], v[80:95]
    s_add_u32 m0, s92, 69632
    s_add_u32 s35, s83, 524288
    buffer_load_dwordx4 v26, s[84:87], s35 offen lds
    v_mfma_f32_16x16x32_bf16 v[28:31], v[16:19], v[44:47], v[28:31]
    s_add_u32 m0, s92, 73728
    s_add_u32 s35, s83, 557056
    buffer_load_dwordx4 v26, s[84:87], s35 offen lds
    s_waitcnt lgkmcnt(0)
    v_mfma_f32_32x32x16_bf16 v[80:95], v[48:51], v[208:211], v[80:95]
    s_add_u32 m0, s92, 77824
    s_add_u32 s35, s83, 589824
    buffer_load_dwordx4 v26, s[84:87], s35 offen lds
    v_mfma_f32_16x16x32_bf16 v[28:31], v[16:19], v[48:51], v[28:31]
    v_mfma_f32_32x32x16_bf16 v[80:95], v[52:55], v[212:215], v[80:95]
    s_add_u32 m0, s92, 81920
    s_add_u32 s35, s83, 622592
    buffer_load_dwordx4 v26, s[84:87], s35 offen lds
    v_mfma_f32_16x16x32_bf16 v[28:31], v[16:19], v[52:55], v[28:31]
    v_mfma_f32_32x32x16_bf16 v[80:95], v[56:59], v[216:219], v[80:95]
    v_mfma_f32_16x16x32_bf16 v[28:31], v[16:19], v[56:59], v[28:31]
    s_add_u32 m0, s92, 86016
    s_add_u32 s35, s83, 655360
    buffer_load_dwordx4 v26, s[84:87], s35 offen lds
    v_mfma_f32_32x32x16_bf16 v[80:95], v[60:63], v[220:223], v[80:95]
    v_mfma_f32_16x16x32_bf16 v[28:31], v[16:19], v[60:63], v[28:31]
    v_mov_b32 v53, v79
    v_mov_b32 v56, v76
    v_mov_b32 v57, v77
    v_cmp_gt_u32 vcc, 32, v1
    v_mov_b32 v66, 0
    v_mov_b32 v67, 0
    v_mul_f32 v11, 0xbb000000, v56
    v_mul_f32 v10, 0x3b000000, v57
    v_cvt_pk_bf16_f32 v59, v11, v11
    v_fma_f32 v10, -v11, v11, v10
    v_and_b32 v60, s34, v59
    v_max_f32 v10, 0, v10
    v_sub_f32 v61, v11, v60
    v_add_f32 v10, 0x3727c5ac, v10
    v_cvt_pk_bf16_f32 v59, v60, v61
    v_rsq_f32 v58, v10
    v_cndmask_b32 v64, 0, v59, vcc
    v_cndmask_b32 v65, 0, v59, vcc
    v_mov_b32 v30, v28
    v_cvt_pk_bf16_f32 v28, v30, v30
    v_and_b32 v29, s34, v28
    v_sub_f32 v29, v30, v29
    v_cvt_pk_bf16_f32 v29, v29, v29
    v_mov_b32 v30, 0
    v_mov_b32 v31, 0
    s_nop 1
    v_mfma_f32_32x32x16_bf16 v[80:95], v[28:31], v[64:67], v[80:95]
    v_mul_f32 v9, 0xc0135761, v58
    v_mul_f32 v8, v58, v58
    v_mul_f32 v8, v8, v9
    v_mul_f32 v8, 0x3d372713, v8
    v_lshlrev_b32 v12, 4, v1
    s_nop 7
    v_pk_mul_f32 v[36:37], v[80:81], v[80:81]
    v_pk_mul_f32 v[38:39], v[82:83], v[82:83]
    v_pk_mul_f32 v[40:41], v[84:85], v[84:85]
    v_pk_mul_f32 v[42:43], v[86:87], v[86:87]
    v_pk_fma_f32 v[36:37], v[36:37], v[8:9], v[8:9] op_sel:[0,0,1] op_sel_hi:[1,0,1]
    v_pk_fma_f32 v[38:39], v[38:39], v[8:9], v[8:9] op_sel:[0,0,1] op_sel_hi:[1,0,1]
    v_pk_fma_f32 v[40:41], v[40:41], v[8:9], v[8:9] op_sel:[0,0,1] op_sel_hi:[1,0,1]
    v_pk_fma_f32 v[42:43], v[42:43], v[8:9], v[8:9] op_sel:[0,0,1] op_sel_hi:[1,0,1]
    v_pk_mul_f32 v[36:37], v[36:37], v[80:81]
    v_pk_mul_f32 v[38:39], v[38:39], v[82:83]
    v_pk_mul_f32 v[40:41], v[40:41], v[84:85]
    v_pk_mul_f32 v[42:43], v[42:43], v[86:87]
    v_exp_f32 v36, v36
    v_exp_f32 v37, v37
    v_exp_f32 v38, v38
    v_exp_f32 v39, v39
    v_exp_f32 v40, v40
    v_exp_f32 v41, v41
    v_exp_f32 v42, v42
    v_exp_f32 v43, v43
    v_pk_mul_f32 v[80:81], v[80:81], v[88:89]
    v_pk_mul_f32 v[82:83], v[82:83], v[90:91]
    v_pk_mul_f32 v[84:85], v[84:85], v[92:93]
    v_pk_mul_f32 v[86:87], v[86:87], v[94:95]
    v_pk_fma_f32 v[36:37], v[36:37], v[10:11], v[10:11] op_sel_hi:[1,0,0]
    v_pk_fma_f32 v[38:39], v[38:39], v[10:11], v[10:11] op_sel_hi:[1,0,0]
    v_pk_fma_f32 v[40:41], v[40:41], v[10:11], v[10:11] op_sel_hi:[1,0,0]
    v_pk_fma_f32 v[42:43], v[42:43], v[10:11], v[10:11] op_sel_hi:[1,0,0]
    v_rcp_f32 v36, v36
    v_rcp_f32 v37, v37
    v_rcp_f32 v38, v38
    v_rcp_f32 v39, v39
    v_rcp_f32 v40, v40
    v_rcp_f32 v41, v41
    v_rcp_f32 v42, v42
    v_rcp_f32 v43, v43
    s_nop 0
    v_pk_mul_f32 v[80:81], v[80:81], v[36:37]
    v_pk_mul_f32 v[82:83], v[82:83], v[38:39]
    v_pk_mul_f32 v[84:85], v[84:85], v[40:41]
    v_pk_mul_f32 v[86:87], v[86:87], v[42:43]
    v_cvt_pk_bf16_f32 v88, v80, v81
    v_cvt_pk_bf16_f32 v89, v82, v83
    v_cvt_pk_bf16_f32 v90, v84, v85
    v_cvt_pk_bf16_f32 v91, v86, v87
    s_nop 1
    v_permlane32_swap_b32 v88, v90
    v_permlane32_swap_b32 v89, v91
    buffer_store_dwordx4 v[88:91], v12, s[52:55], s33 offen sc1
    v_lshrrev_b32 v16, 4, v1
    v_and_b32 v18, 1, v16
    v_bfe_u32 v20, v1, 3, 1
    v_lshl_add_u32 v20, v18, 1, v20
    v_lshlrev_b32 v20, 5, v20
    v_bfe_u32 v21, v1, 2, 2
    v_lshl_add_u32 v20, v21, 7, v20
    v_and_b32 v21, 3, v1
    v_lshl_add_u32 v20, v21, 3, v20
    v_lshl_add_u32 v2, v16, 10, v20
    s_and_b32 s35, s23, 1
    s_lshl_b32 s35, s35, 12
    v_add_u32 v2, s35, v2
    v_xor_b32 v3, 32, v2
    v_xor_b32 v4, 64, v2
    v_xor_b32 v5, 96, v2
    v_add_u32 v6, 0xc000, v2
    v_add_u32 v7, 0xc000, v3
    v_add_u32 v8, 0xc000, v4
    v_add_u32 v9, 0xc000, v5
    v_add_u32 v10, 0x18000, v2
    v_add_u32 v11, 0x18000, v3
    v_add_u32 v12, 0x18000, v4
    v_add_u32 v13, 0x18000, v5
    s_lshr_b32 s69, s23, 1
    s_and_b32 s27, s23, 1
    v_and_b32 v17, 15, v1
    v_lshrrev_b32 v19, 1, v16
    s_lshl_b32 s38, s69, 5
    s_add_u32 s38, s38, s80
    s_lshl_b32 s35, s27, 10
    s_add_u32 s38, s38, s35
    s_lshl_b32 s38, s38, 10
    s_lshl_b32 s35, s81, 7
    s_add_u32 s38, s38, s35
    v_lshlrev_b32 v21, 5, v18
    v_lshl_add_u32 v21, v19, 4, v21
    v_lshl_add_u32 v15, v17, 16, v21
    v_lshlrev_b32 v21, 4, v17
    v_lshl_add_u32 v14, v16, 9, v21
    s_lshl_b32 s35, s27, 8
    v_add_u32 v14, s35, v14
    v_xor_b32 v68, 0x100, v14
    s_mov_b32 s36, 0xffff0000
    s_mov_b32 s34, 0xbfb8aa3b
    s_lshl_b32 s35, s20, 11
    s_add_u32 s35, s35, 53248
    v_lshl_add_u32 v25, v1, 4, s35
    s_xor_b32 s35, s20, 1
    s_lshl_b32 s35, s35, 11
    s_add_u32 s35, s35, 53248
    v_lshl_add_u32 v24, v1, 4, s35
    v_add_u32 v69, 8192, v25
    v_add_u32 v70, 8192, v24
    s_lshl_b32 s35, s23, 11
    s_add_u32 s35, s35, 155648
    v_lshl_add_u32 v23, v1, 3, s35
    v_and_b32 v21, 7, v1
    v_xor_b32 v20, v19, v21
    v_lshlrev_b32 v20, 4, v20
    v_lshl_add_u32 v20, v18, 3, v20
    v_lshl_add_u32 v20, v17, 7, v20
    s_mul_i32 s40, s69, 151552
    s_lshl_b32 s35, s27, 11
    s_add_u32 s40, s40, s35
    v_add_u32 v18, s40, v20
    v_xor_b32 v19, 32, v18
    s_and_b32 s35, s81, 1
    s_lshl_b32 s35, s35, 1
    s_sub_i32 s35, 1, s35
    v_lshl_add_u32 v22, s23, 4, v17
    v_cmp_eq_u32 s[42:43], 0, v22
    v_mul_i32_i24 v22, s35, v22
    v_and_b32 v22, 63, v22
    v_lshlrev_b32 v22, 2, v22
    v_lshl_add_u32 v27, v16, 10, v22
    v_lshlrev_b32 v61, 4, v17
    v_lshl_add_u32 v61, v16, 10, v61
    v_lshlrev_b32 v62, 10, v17
    v_lshlrev_b32 v63, 4, v16
    v_lshrrev_b32 v20, 3, v1
    v_xor_b32 v21, v20, v21
    v_lshlrev_b32 v21, 4, v21
    v_lshl_add_u32 v20, v20, 16, v21
    s_add_u32 s37, s38, 523264
    s_mov_b32 s65, 8519680
    v_lshrrev_b32 v60, 1, v1
    v_lshlrev_b32 v60, 7, v60
    v_and_b32 v21, 1, v1
    v_lshl_add_u32 v60, v21, 3, v60
    s_lshl_b32 s35, s23, 9
    s_add_u32 s35, s35, 155648
    v_lshl_add_u32 v22, v1, 3, s35
    s_lshl_b32 s26, s69, 5
    s_add_u32 s26, s26, s80
    s_mul_i32 s26, s26, 88064
    s_lshl_b32 s35, s27, 11
    s_add_u32 s26, s26, s35
    s_add_u32 s26, s26, 4096
    s_add_u32 s30, s26, 81920
    s_mov_b32 s56, s76
    s_mov_b32 s57, s77
    s_mov_b32 s58, 0x200000
    s_mov_b32 s59, 0x20000
    s_lshl_b32 s35, s81, 2
    s_lshr_b32 s35, 0x43dae170, s35
    s_and_b32 s31, s35, 3
    s_bfe_u32 s32, s35, 0x20002
    s_sub_u32 s33, 32, s80
    s_and_b32 s33, s33, 31
    s_cmp_ge_u32 s81, 4
    s_cselect_b32 s33, s33, s80
    s_lshl_b32 s33, s33, 2
    s_add_u32 s33, s33, s23
    s_lshl_b32 s33, s33, 14
    s_add_u32 s33, s33, 6291456
    s_lshl_b32 s32, s32, 8
    s_add_u32 s32, s32, s33
    s_cmp_eq_u32 s81, 0
    s_cselect_b32 s32, 0x40000000, s32
    s_lshl_b32 s31, s31, 8
    s_add_u32 s33, s33, s31
    s_waitcnt vmcnt(0)
    s_barrier
    s_add_u32 m0, s92, 90112
    s_add_u32 s35, s83, 688128
    buffer_load_dwordx4 v26, s[84:87], s35 offen lds
    s_add_u32 m0, s92, 94208
    s_add_u32 s35, s83, 720896
    buffer_load_dwordx4 v26, s[84:87], s35 offen lds
    s_add_u32 m0, s92, 98304
    s_add_u32 s35, s83, 753664
    buffer_load_dwordx4 v26, s[84:87], s35 offen lds
    s_add_u32 m0, s92, 102400
    s_add_u32 s35, s83, 786432
    buffer_load_dwordx4 v26, s[84:87], s35 offen lds
    s_add_u32 m0, s92, 106496
    s_add_u32 s35, s83, 819200
    buffer_load_dwordx4 v26, s[84:87], s35 offen lds
    s_add_u32 m0, s92, 110592
    s_add_u32 s35, s83, 851968
    buffer_load_dwordx4 v26, s[84:87], s35 offen lds
    s_add_u32 m0, s92, 114688
    s_add_u32 s35, s83, 884736
    buffer_load_dwordx4 v26, s[84:87], s35 offen lds
    s_add_u32 m0, s92, 118784
    s_add_u32 s35, s83, 917504
    buffer_load_dwordx4 v26, s[84:87], s35 offen lds
    s_add_u32 m0, s92, 122880
    s_add_u32 s35, s83, 950272
    buffer_load_dwordx4 v26, s[84:87], s35 offen lds
    s_add_u32 m0, s92, 126976
    s_add_u32 s35, s83, 983040
    buffer_load_dwordx4 v26, s[84:87], s35 offen lds
    s_add_u32 m0, s92, 131072
    s_add_u32 s35, s83, 1015808
    buffer_load_dwordx4 v26, s[84:87], s35 offen lds
    s_add_u32 m0, s92, 135168
    s_add_u32 s35, s83, 1048576
    buffer_load_dwordx4 v26, s[84:87], s35 offen lds
    s_add_u32 m0, s92, 139264
    s_add_u32 s35, s83, 1081344
    buffer_load_dwordx4 v26, s[84:87], s35 offen lds
    s_add_u32 m0, s92, 143360
    s_add_u32 s35, s83, 1114112
    buffer_load_dwordx4 v26, s[84:87], s35 offen lds
    s_add_u32 m0, s92, 147456
    s_add_u32 s35, s83, 1146880
    buffer_load_dwordx4 v26, s[84:87], s35 offen lds
    ds_read_b64_tr_b16 v[120:121], v2 offset:4096
    ds_read_b64_tr_b16 v[122:123], v2 offset:4608
    ds_read_b64_tr_b16 v[124:125], v3 offset:4096
    ds_read_b64_tr_b16 v[126:127], v3 offset:4608
    ds_read_b64_tr_b16 v[128:129], v4 offset:4096
    ds_read_b64_tr_b16 v[130:131], v4 offset:4608
    ds_read_b64_tr_b16 v[132:133], v5 offset:4096
    ds_read_b64_tr_b16 v[134:135], v5 offset:4608
    ds_read_b64_tr_b16 v[136:137], v2 offset:20480
    ds_read_b64_tr_b16 v[138:139], v2 offset:20992
    ds_read_b64_tr_b16 v[140:141], v3 offset:20480
    ds_read_b64_tr_b16 v[142:143], v3 offset:20992
    ds_read_b64_tr_b16 v[144:145], v4 offset:20480
    ds_read_b64_tr_b16 v[146:147], v4 offset:20992
    ds_read_b64_tr_b16 v[148:149], v5 offset:20480
    ds_read_b64_tr_b16 v[150:151], v5 offset:20992
    ds_read_b64_tr_b16 v[152:153], v2 offset:36864
    ds_read_b64_tr_b16 v[154:155], v2 offset:37376
    ds_read_b64_tr_b16 v[156:157], v3 offset:36864
    ds_read_b64_tr_b16 v[158:159], v3 offset:37376
    ds_read_b64_tr_b16 v[160:161], v4 offset:36864
    ds_read_b64_tr_b16 v[162:163], v4 offset:37376
    ds_read_b64_tr_b16 v[164:165], v5 offset:36864
    ds_read_b64_tr_b16 v[166:167], v5 offset:37376
    s_waitcnt vmcnt(12) lgkmcnt(0)
    s_branch L_p2h1
L_dft:
    v_lshrrev_b32 v14, 5, v1
    v_bfe_u32 v8, v1, 4, 1
    v_and_b32 v9, 3, v1
    v_lshl_add_u32 v8, v8, 2, v9
    v_bfe_u32 v9, v1, 3, 1
    v_lshl_add_u32 v9, v14, 2, v9
    v_and_b32 v10, 6, v8
    v_xor_b32 v9, v9, v10
    v_lshlrev_b32 v9, 4, v9
    v_lshl_add_u32 v9, v8, 7, v9
    v_bfe_u32 v10, v1, 2, 1
    v_lshl_add_u32 v9, v10, 3, v9
    s_lshl_b32 s35, s36, 12
    v_add_u32 v51, s35, v9
    v_xor_b32 v5, 32, v51
    v_xor_b32 v48, 16, v51
    v_xor_b32 v49, 16, v5
    v_and_b32 v15, 31, v1
    v_bfe_u32 v9, v1, 1, 3
    v_xor_b32 v9, v9, v14
    v_lshlrev_b32 v9, 4, v9
    v_lshl_add_u32 v9, v15, 7, v9
    s_lshl_b32 s35, s37, 12
    s_lshl_b32 s82, s21, 5
    s_add_u32 s82, s82, s23
    s_lshl_b32 s82, s82, 2
    s_add_u32 s82, s82, 8519680
    s_add_u32 s35, s35, 65536
    v_add_u32 v6, s35, v9
    v_lshl_add_u32 v13, s37, 5, v15
    v_cmp_eq_u32 s[42:43], 0, v13
    v_cvt_f32_u32 v13, v13
    v_mul_f32 v13, 0xbb000000, v13
    v_add_f32 v7, v13, v13
    v_cos_f32 v10, v13
    v_sin_f32 v11, v13
    v_cos_f32 v8, v7
    v_sin_f32 v9, v7
    v_mov_b32 v12, 0x3f3504f3
    v_cvt_f32_u32 v13, v15
    v_mul_f32 v13, 0x3d000000, v13
    v_cvt_f32_u32 v50, v14
    v_mul_f32 v50, v50, v13
    v_fmamk_f32 v7, v13, 0x00000000, v50
    v_fract_f32 v7, v7
    v_cos_f32 v16, v7
    v_sin_f32 v32, v7
    v_fmamk_f32 v7, v13, 0x40000000, v50
    v_fract_f32 v7, v7
    v_cos_f32 v17, v7
    v_sin_f32 v33, v7
    v_fmamk_f32 v7, v13, 0x40800000, v50
    v_fract_f32 v7, v7
    v_cos_f32 v18, v7
    v_sin_f32 v34, v7
    v_fmamk_f32 v7, v13, 0x40c00000, v50
    v_fract_f32 v7, v7
    v_cos_f32 v19, v7
    v_sin_f32 v35, v7
    v_fmamk_f32 v7, v13, 0x41000000, v50
    v_fract_f32 v7, v7
    v_cos_f32 v20, v7
    v_sin_f32 v36, v7
    v_fmamk_f32 v7, v13, 0x41200000, v50
    v_fract_f32 v7, v7
    v_cos_f32 v21, v7
    v_sin_f32 v37, v7
    v_fmamk_f32 v7, v13, 0x41400000, v50
    v_fract_f32 v7, v7
    v_cos_f32 v22, v7
    v_sin_f32 v38, v7
    v_fmamk_f32 v7, v13, 0x41600000, v50
    v_fract_f32 v7, v7
    v_cos_f32 v23, v7
    v_sin_f32 v39, v7
    v_fmamk_f32 v7, v13, 0x41800000, v50
    v_fract_f32 v7, v7
    v_cos_f32 v24, v7
    v_sin_f32 v40, v7
    v_fmamk_f32 v7, v13, 0x41900000, v50
    v_fract_f32 v7, v7
    v_cos_f32 v25, v7
    v_sin_f32 v41, v7
    v_fmamk_f32 v7, v13, 0x41a00000, v50
    v_fract_f32 v7, v7
    v_cos_f32 v26, v7
    v_sin_f32 v42, v7
    v_fmamk_f32 v7, v13, 0x41b00000, v50
    v_fract_f32 v7, v7
    v_cos_f32 v27, v7
    v_sin_f32 v43, v7
    v_fmamk_f32 v7, v13, 0x41c00000, v50
    v_fract_f32 v7, v7
    v_cos_f32 v28, v7
    v_sin_f32 v44, v7
    v_fmamk_f32 v7, v13, 0x41d00000, v50
    v_fract_f32 v7, v7
    v_cos_f32 v29, v7
    v_sin_f32 v45, v7
    v_fmamk_f32 v7, v13, 0x41e00000, v50
    v_fract_f32 v7, v7
    v_cos_f32 v30, v7
    v_sin_f32 v46, v7
    v_fmamk_f32 v7, v13, 0x41f00000, v50
    v_fract_f32 v7, v7
    v_cos_f32 v31, v7
    v_sin_f32 v47, v7
    s_add_u32 m0, s30, 81792
    s_nop 0
    buffer_load_dwordx4 v3, s[72:75], s31 offen offset:128 lds
    buffer_load_dwordx4 v4, s[72:75], s31 offen offset:1152 lds
    s_add_u32 m0, s26, 32256
    s_nop 0
    buffer_load_dwordx4 v2, s[44:47], s25 offen offset:512 lds
    s_add_u32 m0, s26, 40320
    s_nop 0
    buffer_load_dwordx4 v2, s[44:47], s25 offen offset:640 lds
    s_add_u32 m0, s26, 48384
    s_nop 0
    buffer_load_dwordx4 v2, s[44:47], s25 offen offset:768 lds
    s_add_u32 m0, s26, 56448
    s_nop 0
    buffer_load_dwordx4 v2, s[44:47], s25 offen offset:896 lds
    s_lshl_b32 s38, s36, 5
    s_add_u32 s38, s38, s21
    s_lshl_b32 s60, s38, 10
    s_lshl_b32 s35, s37, 7
    s_add_u32 s60, s60, s35
    s_add_u32 s60, s60, 6291456
    s_add_u32 s61, s60, 65536
    s_add_u32 s62, s60, 131072
    s_add_u32 s63, s60, 196608
    s_add_u32 s64, s60, 524288
    s_add_u32 s65, s60, 589824
    s_add_u32 s66, s60, 655360
    s_add_u32 s67, s60, 720896
    s_add_u32 s68, s60, 1048576
    s_add_u32 s69, s60, 1114112
    s_add_u32 s70, s60, 1179648
    s_add_u32 s71, s60, 1245184
    s_add_u32 s72, s60, 1572864
    s_add_u32 s73, s60, 1638400
    s_add_u32 s74, s60, 1703936
    s_add_u32 s75, s60, 1769472
    s_setprio 2
    s_waitcnt vmcnt(8)
    s_barrier
    v_xor_b32 v7, 0, v6
    ds_read_b128 v[88:91], v7
    ds_read_b128 v[92:95], v7 offset:8192
    ds_read_b64_tr_b16 v[56:57], v51
    ds_read_b64_tr_b16 v[58:59], v5
    ds_read_b64_tr_b16 v[60:61], v48 offset:1024
    ds_read_b64_tr_b16 v[62:63], v49 offset:1024
    ds_read_b64_tr_b16 v[64:65], v51 offset:2048
    ds_read_b64_tr_b16 v[66:67], v5 offset:2048
    ds_read_b64_tr_b16 v[68:69], v48 offset:3072
    ds_read_b64_tr_b16 v[70:71], v49 offset:3072
    s_waitcnt lgkmcnt(0)
    v_mfma_f32_32x32x16_bf16 v[128:143], v[56:59], v[88:91], 0
    v_xor_b32 v7, 32, v6
    ds_read_b128 v[96:99], v7
    v_mfma_f32_32x32x16_bf16 v[160:175], v[60:63], v[88:91], 0
    ds_read_b128 v[100:103], v7 offset:8192
    ds_read_b64_tr_b16 v[72:73], v51 offset:8192
    v_mfma_f32_32x32x16_bf16 v[192:207], v[64:67], v[88:91], 0
    ds_read_b64_tr_b16 v[74:75], v5 offset:8192
    ds_read_b64_tr_b16 v[76:77], v48 offset:9216
    v_mfma_f32_32x32x16_bf16 v[224:239], v[68:71], v[88:91], 0
    ds_read_b64_tr_b16 v[78:79], v49 offset:9216
    ds_read_b64_tr_b16 v[80:81], v51 offset:10240
    v_mfma_f32_32x32x16_bf16 v[144:159], v[56:59], v[92:95], 0
    ds_read_b64_tr_b16 v[82:83], v5 offset:10240
    ds_read_b64_tr_b16 v[84:85], v48 offset:11264
    v_mfma_f32_32x32x16_bf16 v[176:191], v[60:63], v[92:95], 0
    ds_read_b64_tr_b16 v[86:87], v49 offset:11264
    v_mfma_f32_32x32x16_bf16 v[208:223], v[64:67], v[92:95], 0
    v_mfma_f32_32x32x16_bf16 v[240:255], v[68:71], v[92:95], 0
    s_waitcnt lgkmcnt(0)
    v_mfma_f32_32x32x16_bf16 v[128:143], v[72:75], v[96:99], v[128:143]
    v_mfma_f32_32x32x16_bf16 v[160:175], v[76:79], v[96:99], v[160:175]
    v_mfma_f32_32x32x16_bf16 v[192:207], v[80:83], v[96:99], v[192:207]
    s_waitcnt vmcnt(6)
    s_barrier
    v_mfma_f32_32x32x16_bf16 v[224:239], v[84:87], v[96:99], v[224:239]
    v_xor_b32 v7, 64, v6
    ds_read_b128 v[88:91], v7
    ds_read_b128 v[92:95], v7 offset:8192
    v_mfma_f32_32x32x16_bf16 v[144:159], v[72:75], v[100:103], v[144:159]
    ds_read_b64_tr_b16 v[56:57], v51 offset:16384
    ds_read_b64_tr_b16 v[58:59], v5 offset:16384
    ds_read_b64_tr_b16 v[60:61], v48 offset:17408
    v_mfma_f32_32x32x16_bf16 v[176:191], v[76:79], v[100:103], v[176:191]
    ds_read_b64_tr_b16 v[62:63], v49 offset:17408
    ds_read_b64_tr_b16 v[64:65], v51 offset:18432
    ds_read_b64_tr_b16 v[66:67], v5 offset:18432
    v_mfma_f32_32x32x16_bf16 v[208:223], v[80:83], v[100:103], v[208:223]
    ds_read_b64_tr_b16 v[68:69], v48 offset:19456
    ds_read_b64_tr_b16 v[70:71], v49 offset:19456
    v_mfma_f32_32x32x16_bf16 v[240:255], v[84:87], v[100:103], v[240:255]
    s_waitcnt lgkmcnt(0)
    v_mfma_f32_32x32x16_bf16 v[128:143], v[56:59], v[88:91], v[128:143]
    v_xor_b32 v7, 96, v6
    ds_read_b128 v[96:99], v7
    v_mfma_f32_32x32x16_bf16 v[160:175], v[60:63], v[88:91], v[160:175]
    ds_read_b128 v[100:103], v7 offset:8192
    ds_read_b64_tr_b16 v[72:73], v51 offset:24576
    v_mfma_f32_32x32x16_bf16 v[192:207], v[64:67], v[88:91], v[192:207]
    ds_read_b64_tr_b16 v[74:75], v5 offset:24576
    ds_read_b64_tr_b16 v[76:77], v48 offset:25600
    v_mfma_f32_32x32x16_bf16 v[224:239], v[68:71], v[88:91], v[224:239]
    ds_read_b64_tr_b16 v[78:79], v49 offset:25600
    ds_read_b64_tr_b16 v[80:81], v51 offset:26624
    v_mfma_f32_32x32x16_bf16 v[144:159], v[56:59], v[92:95], v[144:159]
    ds_read_b64_tr_b16 v[82:83], v5 offset:26624
    ds_read_b64_tr_b16 v[84:85], v48 offset:27648
    v_mfma_f32_32x32x16_bf16 v[176:191], v[60:63], v[92:95], v[176:191]
    ds_read_b64_tr_b16 v[86:87], v49 offset:27648
    v_mfma_f32_32x32x16_bf16 v[208:223], v[64:67], v[92:95], v[208:223]
    v_mfma_f32_32x32x16_bf16 v[240:255], v[68:71], v[92:95], v[240:255]
    s_waitcnt lgkmcnt(0)
    v_mfma_f32_32x32x16_bf16 v[128:143], v[72:75], v[96:99], v[128:143]
    v_mfma_f32_32x32x16_bf16 v[160:175], v[76:79], v[96:99], v[160:175]
    v_mfma_f32_32x32x16_bf16 v[192:207], v[80:83], v[96:99], v[192:207]
    s_waitcnt vmcnt(2)
    s_barrier
    v_mfma_f32_32x32x16_bf16 v[224:239], v[84:87], v[96:99], v[224:239]
    v_xor_b32 v7, 0, v6
    ds_read_b128 v[88:91], v7 offset:16384
    ds_read_b128 v[92:95], v7 offset:24576
    v_mfma_f32_32x32x16_bf16 v[144:159], v[72:75], v[100:103], v[144:159]
    ds_read_b64_tr_b16 v[56:57], v51 offset:32768
    ds_read_b64_tr_b16 v[58:59], v5 offset:32768
    ds_read_b64_tr_b16 v[60:61], v48 offset:33792
    v_mfma_f32_32x32x16_bf16 v[176:191], v[76:79], v[100:103], v[176:191]
    ds_read_b64_tr_b16 v[62:63], v49 offset:33792
    ds_read_b64_tr_b16 v[64:65], v51 offset:34816
    ds_read_b64_tr_b16 v[66:67], v5 offset:34816
    v_mfma_f32_32x32x16_bf16 v[208:223], v[80:83], v[100:103], v[208:223]
    ds_read_b64_tr_b16 v[68:69], v48 offset:35840
    ds_read_b64_tr_b16 v[70:71], v49 offset:35840
    v_mfma_f32_32x32x16_bf16 v[240:255], v[84:87], v[100:103], v[240:255]
    s_waitcnt lgkmcnt(0)
    v_mfma_f32_32x32x16_bf16 v[128:143], v[56:59], v[88:91], v[128:143]
    v_xor_b32 v7, 32, v6
    ds_read_b128 v[96:99], v7 offset:16384
    v_mfma_f32_32x32x16_bf16 v[160:175], v[60:63], v[88:91], v[160:175]
    ds_read_b128 v[100:103], v7 offset:24576
    ds_read_b64_tr_b16 v[72:73], v51 offset:40960
    v_mfma_f32_32x32x16_bf16 v[192:207], v[64:67], v[88:91], v[192:207]
    ds_read_b64_tr_b16 v[74:75], v5 offset:40960
    ds_read_b64_tr_b16 v[76:77], v48 offset:41984
    v_mfma_f32_32x32x16_bf16 v[224:239], v[68:71], v[88:91], v[224:239]
    ds_read_b64_tr_b16 v[78:79], v49 offset:41984
    ds_read_b64_tr_b16 v[80:81], v51 offset:43008
    v_mfma_f32_32x32x16_bf16 v[144:159], v[56:59], v[92:95], v[144:159]
    ds_read_b64_tr_b16 v[82:83], v5 offset:43008
    ds_read_b64_tr_b16 v[84:85], v48 offset:44032
    v_mfma_f32_32x32x16_bf16 v[176:191], v[60:63], v[92:95], v[176:191]
    ds_read_b64_tr_b16 v[86:87], v49 offset:44032
    v_mfma_f32_32x32x16_bf16 v[208:223], v[64:67], v[92:95], v[208:223]
    v_mfma_f32_32x32x16_bf16 v[240:255], v[68:71], v[92:95], v[240:255]
    s_waitcnt lgkmcnt(0)
    v_mfma_f32_32x32x16_bf16 v[128:143], v[72:75], v[96:99], v[128:143]
    v_mfma_f32_32x32x16_bf16 v[160:175], v[76:79], v[96:99], v[160:175]
    v_mfma_f32_32x32x16_bf16 v[192:207], v[80:83], v[96:99], v[192:207]
    s_waitcnt vmcnt(0)
    s_barrier
    v_mfma_f32_32x32x16_bf16 v[224:239], v[84:87], v[96:99], v[224:239]
    v_xor_b32 v7, 64, v6
    ds_read_b128 v[88:91], v7 offset:16384
    ds_read_b128 v[92:95], v7 offset:24576
    v_mfma_f32_32x32x16_bf16 v[144:159], v[72:75], v[100:103], v[144:159]
    ds_read_b64_tr_b16 v[56:57], v51 offset:49152
    ds_read_b64_tr_b16 v[58:59], v5 offset:49152
    ds_read_b64_tr_b16 v[60:61], v48 offset:50176
    v_mfma_f32_32x32x16_bf16 v[176:191], v[76:79], v[100:103], v[176:191]
    ds_read_b64_tr_b16 v[62:63], v49 offset:50176
    ds_read_b64_tr_b16 v[64:65], v51 offset:51200
    ds_read_b64_tr_b16 v[66:67], v5 offset:51200
    v_mfma_f32_32x32x16_bf16 v[208:223], v[80:83], v[100:103], v[208:223]
    ds_read_b64_tr_b16 v[68:69], v48 offset:52224
    ds_read_b64_tr_b16 v[70:71], v49 offset:52224
    v_mfma_f32_32x32x16_bf16 v[240:255], v[84:87], v[100:103], v[240:255]
    s_waitcnt lgkmcnt(0)
    v_mfma_f32_32x32x16_bf16 v[128:143], v[56:59], v[88:91], v[128:143]
    v_xor_b32 v7, 96, v6
    ds_read_b128 v[96:99], v7 offset:16384
    v_mfma_f32_32x32x16_bf16 v[160:175], v[60:63], v[88:91], v[160:175]
    ds_read_b128 v[100:103], v7 offset:24576
    ds_read_b64_tr_b16 v[72:73], v51 offset:57344
    v_mfma_f32_32x32x16_bf16 v[192:207], v[64:67], v[88:91], v[192:207]
    ds_read_b64_tr_b16 v[74:75], v5 offset:57344
    ds_read_b64_tr_b16 v[76:77], v48 offset:58368
    v_mfma_f32_32x32x16_bf16 v[224:239], v[68:71], v[88:91], v[224:239]
    ds_read_b64_tr_b16 v[78:79], v49 offset:58368
    ds_read_b64_tr_b16 v[80:81], v51 offset:59392
    v_mfma_f32_32x32x16_bf16 v[144:159], v[56:59], v[92:95], v[144:159]
    ds_read_b64_tr_b16 v[82:83], v5 offset:59392
    ds_read_b64_tr_b16 v[84:85], v48 offset:60416
    v_mfma_f32_32x32x16_bf16 v[176:191], v[60:63], v[92:95], v[176:191]
    ds_read_b64_tr_b16 v[86:87], v49 offset:60416
    v_mfma_f32_32x32x16_bf16 v[208:223], v[64:67], v[92:95], v[208:223]
    v_mfma_f32_32x32x16_bf16 v[240:255], v[68:71], v[92:95], v[240:255]
    s_waitcnt lgkmcnt(0)
    v_mfma_f32_32x32x16_bf16 v[128:143], v[72:75], v[96:99], v[128:143]
    v_mfma_f32_32x32x16_bf16 v[160:175], v[76:79], v[96:99], v[160:175]
    v_mfma_f32_32x32x16_bf16 v[192:207], v[80:83], v[96:99], v[192:207]
    v_mfma_f32_32x32x16_bf16 v[224:239], v[84:87], v[96:99], v[224:239]
    v_mfma_f32_32x32x16_bf16 v[144:159], v[72:75], v[100:103], v[144:159]
    v_mfma_f32_32x32x16_bf16 v[176:191], v[76:79], v[100:103], v[176:191]
    v_mfma_f32_32x32x16_bf16 v[208:223], v[80:83], v[100:103], v[208:223]
    v_mfma_f32_32x32x16_bf16 v[240:255], v[84:87], v[100:103], v[240:255]
    s_setprio 2
    s_nop 7
    .p2align 3
    v_pk_fma_f32 v[120:121], v[130:131], v[8:9], v[128:129] op_sel:[0,0,0] op_sel_hi:[1,0,1] neg_lo:[0,0,0] neg_hi:[0,0,0]
    v_pk_fma_f32 v[124:125], v[134:135], v[8:9], v[132:133] op_sel:[0,0,0] op_sel_hi:[1,0,1] neg_lo:[0,0,0] neg_hi:[0,0,0]
    v_pk_fma_f32 v[122:123], v[146:147], v[8:9], v[144:145] op_sel:[0,0,0] op_sel_hi:[1,0,1] neg_lo:[0,0,0] neg_hi:[0,0,0]
    v_pk_fma_f32 v[126:127], v[150:151], v[8:9], v[148:149] op_sel:[0,0,0] op_sel_hi:[1,0,1] neg_lo:[0,0,0] neg_hi:[0,0,0]
    v_pk_fma_f32 v[120:121], v[146:147], v[8:9], v[120:121] op_sel:[0,1,0] op_sel_hi:[1,1,1] neg_lo:[0,1,0] neg_hi:[0,1,0]
    v_pk_fma_f32 v[124:125], v[150:151], v[8:9], v[124:125] op_sel:[0,1,0] op_sel_hi:[1,1,1] neg_lo:[0,1,0] neg_hi:[0,1,0]
    v_pk_fma_f32 v[122:123], v[130:131], v[8:9], v[122:123] op_sel:[0,1,0] op_sel_hi:[1,1,1] neg_lo:[0,0,0] neg_hi:[0,0,0]
    v_pk_fma_f32 v[126:127], v[134:135], v[8:9], v[126:127] op_sel:[0,1,0] op_sel_hi:[1,1,1] neg_lo:[0,0,0] neg_hi:[0,0,0]
    v_pk_fma_f32 v[128:129], v[128:129], 2.0, v[120:121] op_sel:[0,0,0] op_sel_hi:[1,0,1] neg_lo:[0,0,1] neg_hi:[0,0,1]
    v_pk_fma_f32 v[132:133], v[132:133], 2.0, v[124:125] op_sel:[0,0,0] op_sel_hi:[1,0,1] neg_lo:[0,0,1] neg_hi:[0,0,1]
    v_pk_fma_f32 v[58:59], v[144:145], 2.0, v[122:123] op_sel:[0,0,0] op_sel_hi:[1,0,1] neg_lo:[0,0,1] neg_hi:[0,0,1]
    v_pk_fma_f32 v[74:75], v[148:149], 2.0, v[126:127] op_sel:[0,0,0] op_sel_hi:[1,0,1] neg_lo:[0,0,1] neg_hi:[0,0,1]
    v_pk_fma_f32 v[130:131], v[120:121], v[10:11], v[120:121] op_sel:[1,0,0] op_sel_hi:[1,0,0] neg_lo:[0,0,0] neg_hi:[0,1,0]
    v_pk_fma_f32 v[134:135], v[124:125], v[10:11], v[124:125] op_sel:[1,0,0] op_sel_hi:[1,0,0] neg_lo:[0,0,0] neg_hi:[0,1,0]
    v_pk_fma_f32 v[60:61], v[122:123], v[10:11], v[122:123] op_sel:[1,0,0] op_sel_hi:[1,0,0] neg_lo:[0,0,0] neg_hi:[0,0,1]
    v_pk_fma_f32 v[76:77], v[126:127], v[10:11], v[126:127] op_sel:[1,0,0] op_sel_hi:[1,0,0] neg_lo:[0,0,0] neg_hi:[0,0,1]
    v_pk_fma_f32 v[66:67], v[58:59], v[10:11], v[128:129] op_sel:[1,0,0] op_sel_hi:[1,0,0] neg_lo:[0,0,0] neg_hi:[0,1,0]
    v_pk_fma_f32 v[82:83], v[74:75], v[10:11], v[132:133] op_sel:[1,0,0] op_sel_hi:[1,0,0] neg_lo:[0,0,0] neg_hi:[0,1,0]
    v_pk_fma_f32 v[68:69], v[128:129], v[10:11], v[58:59] op_sel:[1,0,0] op_sel_hi:[1,0,0] neg_lo:[0,1,0] neg_hi:[0,1,1]
    v_pk_fma_f32 v[84:85], v[132:133], v[10:11], v[74:75] op_sel:[1,0,0] op_sel_hi:[1,0,0] neg_lo:[0,1,0] neg_hi:[0,1,1]
    v_pk_fma_f32 v[130:131], v[122:123], v[10:11], v[130:131] op_sel:[1,1,0] op_sel_hi:[1,1,1] neg_lo:[0,1,0] neg_hi:[0,0,0]
    v_pk_fma_f32 v[134:135], v[126:127], v[10:11], v[134:135] op_sel:[1,1,0] op_sel_hi:[1,1,1] neg_lo:[0,1,0] neg_hi:[0,0,0]
    v_pk_fma_f32 v[60:61], v[120:121], v[10:11], v[60:61] op_sel:[1,1,0] op_sel_hi:[1,1,1] neg_lo:[0,0,0] neg_hi:[0,0,0]
    v_pk_fma_f32 v[76:77], v[124:125], v[10:11], v[76:77] op_sel:[1,1,0] op_sel_hi:[1,1,1] neg_lo:[0,0,0] neg_hi:[0,0,0]
    v_pk_fma_f32 v[66:67], v[128:129], v[10:11], v[66:67] op_sel:[1,1,0] op_sel_hi:[1,1,1] neg_lo:[0,0,0] neg_hi:[0,1,0]
    v_pk_fma_f32 v[82:83], v[132:133], v[10:11], v[82:83] op_sel:[1,1,0] op_sel_hi:[1,1,1] neg_lo:[0,0,0] neg_hi:[0,1,0]
    v_pk_fma_f32 v[68:69], v[58:59], v[10:11], v[68:69] op_sel:[1,1,0] op_sel_hi:[1,1,1] neg_lo:[0,0,0] neg_hi:[0,0,0]
    v_pk_fma_f32 v[84:85], v[74:75], v[10:11], v[84:85] op_sel:[1,1,0] op_sel_hi:[1,1,1] neg_lo:[0,0,0] neg_hi:[0,0,0]
    s_mov_b64 exec, s[42:43]
    v_mov_b32 v130, v128
    v_pk_fma_f32 v[66:67], v[58:59], v[12:13], v[144:145] op_sel:[1,0,0] op_sel_hi:[1,0,0] neg_lo:[0,0,0] neg_hi:[0,1,0]
    v_pk_fma_f32 v[68:69], v[122:123], v[12:13], v[146:147] op_sel:[1,0,0] op_sel_hi:[1,0,0] neg_lo:[0,1,1] neg_hi:[0,1,0]
    v_pk_fma_f32 v[82:83], v[74:75], v[12:13], v[148:149] op_sel:[1,0,0] op_sel_hi:[1,0,0] neg_lo:[0,0,0] neg_hi:[0,1,0]
    v_pk_fma_f32 v[84:85], v[126:127], v[12:13], v[150:151] op_sel:[1,0,0] op_sel_hi:[1,0,0] neg_lo:[0,1,1] neg_hi:[0,1,0]
    v_sub_f32 v60, 0, v129
    v_mov_b32 v61, 0
    v_mov_b32 v134, v132
    v_sub_f32 v76, 0, v133
    v_mov_b32 v77, 0
    s_mov_b64 exec, -1
    v_cvt_pk_bf16_f32 v56, v130, v134
    v_cvt_pk_bf16_f32 v64, v60, v76
    v_cvt_pk_bf16_f32 v72, v66, v82
    v_cvt_pk_bf16_f32 v80, v68, v84
    v_cvt_pk_bf16_f32 v88, v131, v135
    v_cvt_pk_bf16_f32 v96, v61, v77
    v_cvt_pk_bf16_f32 v104, v67, v83
    v_cvt_pk_bf16_f32 v112, v69, v85
    v_pk_fma_f32 v[120:121], v[138:139], v[8:9], v[136:137] op_sel:[0,0,0] op_sel_hi:[1,0,1] neg_lo:[0,0,0] neg_hi:[0,0,0]
    v_pk_fma_f32 v[124:125], v[142:143], v[8:9], v[140:141] op_sel:[0,0,0] op_sel_hi:[1,0,1] neg_lo:[0,0,0] neg_hi:[0,0,0]
    v_pk_fma_f32 v[122:123], v[154:155], v[8:9], v[152:153] op_sel:[0,0,0] op_sel_hi:[1,0,1] neg_lo:[0,0,0] neg_hi:[0,0,0]
    v_pk_fma_f32 v[126:127], v[158:159], v[8:9], v[156:157] op_sel:[0,0,0] op_sel_hi:[1,0,1] neg_lo:[0,0,0] neg_hi:[0,0,0]
    v_pk_fma_f32 v[120:121], v[154:155], v[8:9], v[120:121] op_sel:[0,1,0] op_sel_hi:[1,1,1] neg_lo:[0,1,0] neg_hi:[0,1,0]
    v_pk_fma_f32 v[124:125], v[158:159], v[8:9], v[124:125] op_sel:[0,1,0] op_sel_hi:[1,1,1] neg_lo:[0,1,0] neg_hi:[0,1,0]
    v_pk_fma_f32 v[122:123], v[138:139], v[8:9], v[122:123] op_sel:[0,1,0] op_sel_hi:[1,1,1] neg_lo:[0,0,0] neg_hi:[0,0,0]
    v_pk_fma_f32 v[126:127], v[142:143], v[8:9], v[126:127] op_sel:[0,1,0] op_sel_hi:[1,1,1] neg_lo:[0,0,0] neg_hi:[0,0,0]
    v_pk_fma_f32 v[136:137], v[136:137], 2.0, v[120:121] op_sel:[0,0,0] op_sel_hi:[1,0,1] neg_lo:[0,0,1] neg_hi:[0,0,1]
    v_pk_fma_f32 v[140:141], v[140:141], 2.0, v[124:125] op_sel:[0,0,0] op_sel_hi:[1,0,1] neg_lo:[0,0,1] neg_hi:[0,0,1]
    v_pk_fma_f32 v[128:129], v[152:153], 2.0, v[122:123] op_sel:[0,0,0] op_sel_hi:[1,0,1] neg_lo:[0,0,1] neg_hi:[0,0,1]
    v_pk_fma_f32 v[132:133], v[156:157], 2.0, v[126:127] op_sel:[0,0,0] op_sel_hi:[1,0,1] neg_lo:[0,0,1] neg_hi:[0,0,1]
    v_pk_fma_f32 v[138:139], v[120:121], v[10:11], v[120:121] op_sel:[1,0,0] op_sel_hi:[1,0,0] neg_lo:[0,0,0] neg_hi:[0,1,0]
    v_pk_fma_f32 v[142:143], v[124:125], v[10:11], v[124:125] op_sel:[1,0,0] op_sel_hi:[1,0,0] neg_lo:[0,0,0] neg_hi:[0,1,0]
    v_pk_fma_f32 v[130:131], v[122:123], v[10:11], v[122:123] op_sel:[1,0,0] op_sel_hi:[1,0,0] neg_lo:[0,0,0] neg_hi:[0,0,1]
    v_pk_fma_f32 v[134:135], v[126:127], v[10:11], v[126:127] op_sel:[1,0,0] op_sel_hi:[1,0,0] neg_lo:[0,0,0] neg_hi:[0,0,1]
    v_pk_fma_f32 v[144:145], v[128:129], v[10:11], v[136:137] op_sel:[1,0,0] op_sel_hi:[1,0,0] neg_lo:[0,0,0] neg_hi:[0,1,0]
    v_pk_fma_f32 v[148:149], v[132:133], v[10:11], v[140:141] op_sel:[1,0,0] op_sel_hi:[1,0,0] neg_lo:[0,0,0] neg_hi:[0,1,0]
    v_pk_fma_f32 v[146:147], v[136:137], v[10:11], v[128:129] op_sel:[1,0,0] op_sel_hi:[1,0,0] neg_lo:[0,1,0] neg_hi:[0,1,1]
    v_pk_fma_f32 v[150:151], v[140:141], v[10:11], v[132:133] op_sel:[1,0,0] op_sel_hi:[1,0,0] neg_lo:[0,1,0] neg_hi:[0,1,1]
    v_pk_fma_f32 v[138:139], v[122:123], v[10:11], v[138:139] op_sel:[1,1,0] op_sel_hi:[1,1,1] neg_lo:[0,1,0] neg_hi:[0,0,0]
    v_pk_fma_f32 v[142:143], v[126:127], v[10:11], v[142:143] op_sel:[1,1,0] op_sel_hi:[1,1,1] neg_lo:[0,1,0] neg_hi:[0,0,0]
    v_pk_fma_f32 v[130:131], v[120:121], v[10:11], v[130:131] op_sel:[1,1,0] op_sel_hi:[1,1,1] neg_lo:[0,0,0] neg_hi:[0,0,0]
    v_pk_fma_f32 v[134:135], v[124:125], v[10:11], v[134:135] op_sel:[1,1,0] op_sel_hi:[1,1,1] neg_lo:[0,0,0] neg_hi:[0,0,0]
    v_pk_fma_f32 v[144:145], v[136:137], v[10:11], v[144:145] op_sel:[1,1,0] op_sel_hi:[1,1,1] neg_lo:[0,0,0] neg_hi:[0,1,0]
    v_pk_fma_f32 v[148:149], v[140:141], v[10:11], v[148:149] op_sel:[1,1,0] op_sel_hi:[1,1,1] neg_lo:[0,0,0] neg_hi:[0,1,0]
    v_pk_fma_f32 v[146:147], v[128:129], v[10:11], v[146:147] op_sel:[1,1,0] op_sel_hi:[1,1,1] neg_lo:[0,0,0] neg_hi:[0,0,0]
    v_pk_fma_f32 v[150:151], v[132:133], v[10:11], v[150:151] op_sel:[1,1,0] op_sel_hi:[1,1,1] neg_lo:[0,0,0] neg_hi:[0,0,0]
    s_mov_b64 exec, s[42:43]
    v_mov_b32 v138, v136
    v_pk_fma_f32 v[144:145], v[128:129], v[12:13], v[152:153] op_sel:[1,0,0] op_sel_hi:[1,0,0] neg_lo:[0,0,0] neg_hi:[0,1,0]
    v_pk_fma_f32 v[146:147], v[122:123], v[12:13], v[154:155] op_sel:[1,0,0] op_sel_hi:[1,0,0] neg_lo:[0,1,1] neg_hi:[0,1,0]
    v_pk_fma_f32 v[148:149], v[132:133], v[12:13], v[156:157] op_sel:[1,0,0] op_sel_hi:[1,0,0] neg_lo:[0,0,0] neg_hi:[0,1,0]
    v_pk_fma_f32 v[150:151], v[126:127], v[12:13], v[158:159] op_sel:[1,0,0] op_sel_hi:[1,0,0] neg_lo:[0,1,1] neg_hi:[0,1,0]
    v_sub_f32 v130, 0, v137
    v_mov_b32 v131, 0
    v_mov_b32 v142, v140
    v_sub_f32 v134, 0, v141
    v_mov_b32 v135, 0
    s_mov_b64 exec, -1
    v_cvt_pk_bf16_f32 v57, v138, v142
    v_cvt_pk_bf16_f32 v65, v130, v134
    v_cvt_pk_bf16_f32 v73, v144, v148
    v_cvt_pk_bf16_f32 v81, v146, v150
    v_cvt_pk_bf16_f32 v89, v139, v143
    v_cvt_pk_bf16_f32 v97, v131, v135
    v_cvt_pk_bf16_f32 v105, v145, v149
    v_cvt_pk_bf16_f32 v113, v147, v151
    v_pk_fma_f32 v[120:121], v[162:163], v[8:9], v[160:161] op_sel:[0,0,0] op_sel_hi:[1,0,1] neg_lo:[0,0,0] neg_hi:[0,0,0]
    v_pk_fma_f32 v[124:125], v[166:167], v[8:9], v[164:165] op_sel:[0,0,0] op_sel_hi:[1,0,1] neg_lo:[0,0,0] neg_hi:[0,0,0]
    v_pk_fma_f32 v[122:123], v[178:179], v[8:9], v[176:177] op_sel:[0,0,0] op_sel_hi:[1,0,1] neg_lo:[0,0,0] neg_hi:[0,0,0]
    v_pk_fma_f32 v[126:127], v[182:183], v[8:9], v[180:181] op_sel:[0,0,0] op_sel_hi:[1,0,1] neg_lo:[0,0,0] neg_hi:[0,0,0]
    v_pk_fma_f32 v[120:121], v[178:179], v[8:9], v[120:121] op_sel:[0,1,0] op_sel_hi:[1,1,1] neg_lo:[0,1,0] neg_hi:[0,1,0]
    v_pk_fma_f32 v[124:125], v[182:183], v[8:9], v[124:125] op_sel:[0,1,0] op_sel_hi:[1,1,1] neg_lo:[0,1,0] neg_hi:[0,1,0]
    v_pk_fma_f32 v[122:123], v[162:163], v[8:9], v[122:123] op_sel:[0,1,0] op_sel_hi:[1,1,1] neg_lo:[0,0,0] neg_hi:[0,0,0]
    v_pk_fma_f32 v[126:127], v[166:167], v[8:9], v[126:127] op_sel:[0,1,0] op_sel_hi:[1,1,1] neg_lo:[0,0,0] neg_hi:[0,0,0]
    v_pk_fma_f32 v[160:161], v[160:161], 2.0, v[120:121] op_sel:[0,0,0] op_sel_hi:[1,0,1] neg_lo:[0,0,1] neg_hi:[0,0,1]
    v_pk_fma_f32 v[164:165], v[164:165], 2.0, v[124:125] op_sel:[0,0,0] op_sel_hi:[1,0,1] neg_lo:[0,0,1] neg_hi:[0,0,1]
    v_pk_fma_f32 v[136:137], v[176:177], 2.0, v[122:123] op_sel:[0,0,0] op_sel_hi:[1,0,1] neg_lo:[0,0,1] neg_hi:[0,0,1]
    v_pk_fma_f32 v[140:141], v[180:181], 2.0, v[126:127] op_sel:[0,0,0] op_sel_hi:[1,0,1] neg_lo:[0,0,1] neg_hi:[0,0,1]
    v_pk_fma_f32 v[162:163], v[120:121], v[10:11], v[120:121] op_sel:[1,0,0] op_sel_hi:[1,0,0] neg_lo:[0,0,0] neg_hi:[0,1,0]
    v_pk_fma_f32 v[166:167], v[124:125], v[10:11], v[124:125] op_sel:[1,0,0] op_sel_hi:[1,0,0] neg_lo:[0,0,0] neg_hi:[0,1,0]
    v_pk_fma_f32 v[138:139], v[122:123], v[10:11], v[122:123] op_sel:[1,0,0] op_sel_hi:[1,0,0] neg_lo:[0,0,0] neg_hi:[0,0,1]
    v_pk_fma_f32 v[142:143], v[126:127], v[10:11], v[126:127] op_sel:[1,0,0] op_sel_hi:[1,0,0] neg_lo:[0,0,0] neg_hi:[0,0,1]
    v_pk_fma_f32 v[152:153], v[136:137], v[10:11], v[160:161] op_sel:[1,0,0] op_sel_hi:[1,0,0] neg_lo:[0,0,0] neg_hi:[0,1,0]
    v_pk_fma_f32 v[156:157], v[140:141], v[10:11], v[164:165] op_sel:[1,0,0] op_sel_hi:[1,0,0] neg_lo:[0,0,0] neg_hi:[0,1,0]
    v_pk_fma_f32 v[154:155], v[160:161], v[10:11], v[136:137] op_sel:[1,0,0] op_sel_hi:[1,0,0] neg_lo:[0,1,0] neg_hi:[0,1,1]
    v_pk_fma_f32 v[158:159], v[164:165], v[10:11], v[140:141] op_sel:[1,0,0] op_sel_hi:[1,0,0] neg_lo:[0,1,0] neg_hi:[0,1,1]
    v_pk_fma_f32 v[162:163], v[122:123], v[10:11], v[162:163] op_sel:[1,1,0] op_sel_hi:[1,1,1] neg_lo:[0,1,0] neg_hi:[0,0,0]
    v_pk_fma_f32 v[166:167], v[126:127], v[10:11], v[166:167] op_sel:[1,1,0] op_sel_hi:[1,1,1] neg_lo:[0,1,0] neg_hi:[0,0,0]
    v_pk_fma_f32 v[138:139], v[120:121], v[10:11], v[138:139] op_sel:[1,1,0] op_sel_hi:[1,1,1] neg_lo:[0,0,0] neg_hi:[0,0,0]
    v_pk_fma_f32 v[142:143], v[124:125], v[10:11], v[142:143] op_sel:[1,1,0] op_sel_hi:[1,1,1] neg_lo:[0,0,0] neg_hi:[0,0,0]
    v_pk_fma_f32 v[152:153], v[160:161], v[10:11], v[152:153] op_sel:[1,1,0] op_sel_hi:[1,1,1] neg_lo:[0,0,0] neg_hi:[0,1,0]
    v_pk_fma_f32 v[156:157], v[164:165], v[10:11], v[156:157] op_sel:[1,1,0] op_sel_hi:[1,1,1] neg_lo:[0,0,0] neg_hi:[0,1,0]
    v_pk_fma_f32 v[154:155], v[136:137], v[10:11], v[154:155] op_sel:[1,1,0] op_sel_hi:[1,1,1] neg_lo:[0,0,0] neg_hi:[0,0,0]
    v_pk_fma_f32 v[158:159], v[140:141], v[10:11], v[158:159] op_sel:[1,1,0] op_sel_hi:[1,1,1] neg_lo:[0,0,0] neg_hi:[0,0,0]
    s_mov_b64 exec, s[42:43]
    v_mov_b32 v162, v160
    v_pk_fma_f32 v[152:153], v[136:137], v[12:13], v[176:177] op_sel:[1,0,0] op_sel_hi:[1,0,0] neg_lo:[0,0,0] neg_hi:[0,1,0]
    v_pk_fma_f32 v[154:155], v[122:123], v[12:13], v[178:179] op_sel:[1,0,0] op_sel_hi:[1,0,0] neg_lo:[0,1,1] neg_hi:[0,1,0]
    v_pk_fma_f32 v[156:157], v[140:141], v[12:13], v[180:181] op_sel:[1,0,0] op_sel_hi:[1,0,0] neg_lo:[0,0,0] neg_hi:[0,1,0]
    v_pk_fma_f32 v[158:159], v[126:127], v[12:13], v[182:183] op_sel:[1,0,0] op_sel_hi:[1,0,0] neg_lo:[0,1,1] neg_hi:[0,1,0]
    v_sub_f32 v138, 0, v161
    v_mov_b32 v139, 0
    v_mov_b32 v166, v164
    v_sub_f32 v142, 0, v165
    v_mov_b32 v143, 0
    s_mov_b64 exec, -1
    v_cvt_pk_bf16_f32 v58, v162, v166
    v_cvt_pk_bf16_f32 v66, v138, v142
    v_cvt_pk_bf16_f32 v74, v152, v156
    v_cvt_pk_bf16_f32 v82, v154, v158
    v_cvt_pk_bf16_f32 v90, v163, v167
    v_cvt_pk_bf16_f32 v98, v139, v143
    v_cvt_pk_bf16_f32 v106, v153, v157
    v_cvt_pk_bf16_f32 v114, v155, v159
    v_pk_fma_f32 v[120:121], v[170:171], v[8:9], v[168:169] op_sel:[0,0,0] op_sel_hi:[1,0,1] neg_lo:[0,0,0] neg_hi:[0,0,0]
    v_pk_fma_f32 v[124:125], v[174:175], v[8:9], v[172:173] op_sel:[0,0,0] op_sel_hi:[1,0,1] neg_lo:[0,0,0] neg_hi:[0,0,0]
    v_pk_fma_f32 v[122:123], v[186:187], v[8:9], v[184:185] op_sel:[0,0,0] op_sel_hi:[1,0,1] neg_lo:[0,0,0] neg_hi:[0,0,0]
    v_pk_fma_f32 v[126:127], v[190:191], v[8:9], v[188:189] op_sel:[0,0,0] op_sel_hi:[1,0,1] neg_lo:[0,0,0] neg_hi:[0,0,0]
    v_pk_fma_f32 v[120:121], v[186:187], v[8:9], v[120:121] op_sel:[0,1,0] op_sel_hi:[1,1,1] neg_lo:[0,1,0] neg_hi:[0,1,0]
    v_pk_fma_f32 v[124:125], v[190:191], v[8:9], v[124:125] op_sel:[0,1,0] op_sel_hi:[1,1,1] neg_lo:[0,1,0] neg_hi:[0,1,0]
    v_pk_fma_f32 v[122:123], v[170:171], v[8:9], v[122:123] op_sel:[0,1,0] op_sel_hi:[1,1,1] neg_lo:[0,0,0] neg_hi:[0,0,0]
    v_pk_fma_f32 v[126:127], v[174:175], v[8:9], v[126:127] op_sel:[0,1,0] op_sel_hi:[1,1,1] neg_lo:[0,0,0] neg_hi:[0,0,0]
    v_pk_fma_f32 v[168:169], v[168:169], 2.0, v[120:121] op_sel:[0,0,0] op_sel_hi:[1,0,1] neg_lo:[0,0,1] neg_hi:[0,0,1]
    v_pk_fma_f32 v[172:173], v[172:173], 2.0, v[124:125] op_sel:[0,0,0] op_sel_hi:[1,0,1] neg_lo:[0,0,1] neg_hi:[0,0,1]
    v_pk_fma_f32 v[160:161], v[184:185], 2.0, v[122:123] op_sel:[0,0,0] op_sel_hi:[1,0,1] neg_lo:[0,0,1] neg_hi:[0,0,1]
    v_pk_fma_f32 v[164:165], v[188:189], 2.0, v[126:127] op_sel:[0,0,0] op_sel_hi:[1,0,1] neg_lo:[0,0,1] neg_hi:[0,0,1]
    v_pk_fma_f32 v[170:171], v[120:121], v[10:11], v[120:121] op_sel:[1,0,0] op_sel_hi:[1,0,0] neg_lo:[0,0,0] neg_hi:[0,1,0]
    v_pk_fma_f32 v[174:175], v[124:125], v[10:11], v[124:125] op_sel:[1,0,0] op_sel_hi:[1,0,0] neg_lo:[0,0,0] neg_hi:[0,1,0]
    v_pk_fma_f32 v[162:163], v[122:123], v[10:11], v[122:123] op_sel:[1,0,0] op_sel_hi:[1,0,0] neg_lo:[0,0,0] neg_hi:[0,0,1]
    v_pk_fma_f32 v[166:167], v[126:127], v[10:11], v[126:127] op_sel:[1,0,0] op_sel_hi:[1,0,0] neg_lo:[0,0,0] neg_hi:[0,0,1]
    v_pk_fma_f32 v[176:177], v[160:161], v[10:11], v[168:169] op_sel:[1,0,0] op_sel_hi:[1,0,0] neg_lo:[0,0,0] neg_hi:[0,1,0]
    v_pk_fma_f32 v[180:181], v[164:165], v[10:11], v[172:173] op_sel:[1,0,0] op_sel_hi:[1,0,0] neg_lo:[0,0,0] neg_hi:[0,1,0]
    v_pk_fma_f32 v[178:179], v[168:169], v[10:11], v[160:161] op_sel:[1,0,0] op_sel_hi:[1,0,0] neg_lo:[0,1,0] neg_hi:[0,1,1]
    v_pk_fma_f32 v[182:183], v[172:173], v[10:11], v[164:165] op_sel:[1,0,0] op_sel_hi:[1,0,0] neg_lo:[0,1,0] neg_hi:[0,1,1]
    v_pk_fma_f32 v[170:171], v[122:123], v[10:11], v[170:171] op_sel:[1,1,0] op_sel_hi:[1,1,1] neg_lo:[0,1,0] neg_hi:[0,0,0]
    v_pk_fma_f32 v[174:175], v[126:127], v[10:11], v[174:175] op_sel:[1,1,0] op_sel_hi:[1,1,1] neg_lo:[0,1,0] neg_hi:[0,0,0]
    v_pk_fma_f32 v[162:163], v[120:121], v[10:11], v[162:163] op_sel:[1,1,0] op_sel_hi:[1,1,1] neg_lo:[0,0,0] neg_hi:[0,0,0]
    v_pk_fma_f32 v[166:167], v[124:125], v[10:11], v[166:167] op_sel:[1,1,0] op_sel_hi:[1,1,1] neg_lo:[0,0,0] neg_hi:[0,0,0]
    v_pk_fma_f32 v[176:177], v[168:169], v[10:11], v[176:177] op_sel:[1,1,0] op_sel_hi:[1,1,1] neg_lo:[0,0,0] neg_hi:[0,1,0]
    v_pk_fma_f32 v[180:181], v[172:173], v[10:11], v[180:181] op_sel:[1,1,0] op_sel_hi:[1,1,1] neg_lo:[0,0,0] neg_hi:[0,1,0]
    v_pk_fma_f32 v[178:179], v[160:161], v[10:11], v[178:179] op_sel:[1,1,0] op_sel_hi:[1,1,1] neg_lo:[0,0,0] neg_hi:[0,0,0]
    v_pk_fma_f32 v[182:183], v[164:165], v[10:11], v[182:183] op_sel:[1,1,0] op_sel_hi:[1,1,1] neg_lo:[0,0,0] neg_hi:[0,0,0]
    s_mov_b64 exec, s[42:43]
    v_mov_b32 v170, v168
    v_pk_fma_f32 v[176:177], v[160:161], v[12:13], v[184:185] op_sel:[1,0,0] op_sel_hi:[1,0,0] neg_lo:[0,0,0] neg_hi:[0,1,0]
    v_pk_fma_f32 v[178:179], v[122:123], v[12:13], v[186:187] op_sel:[1,0,0] op_sel_hi:[1,0,0] neg_lo:[0,1,1] neg_hi:[0,1,0]
    v_pk_fma_f32 v[180:181], v[164:165], v[12:13], v[188:189] op_sel:[1,0,0] op_sel_hi:[1,0,0] neg_lo:[0,0,0] neg_hi:[0,1,0]
    v_pk_fma_f32 v[182:183], v[126:127], v[12:13], v[190:191] op_sel:[1,0,0] op_sel_hi:[1,0,0] neg_lo:[0,1,1] neg_hi:[0,1,0]
    v_sub_f32 v162, 0, v169
    v_mov_b32 v163, 0
    v_mov_b32 v174, v172
    v_sub_f32 v166, 0, v173
    v_mov_b32 v167, 0
    s_mov_b64 exec, -1
    v_cvt_pk_bf16_f32 v59, v170, v174
    v_cvt_pk_bf16_f32 v67, v162, v166
    v_cvt_pk_bf16_f32 v75, v176, v180
    v_cvt_pk_bf16_f32 v83, v178, v182
    v_cvt_pk_bf16_f32 v91, v171, v175
    v_cvt_pk_bf16_f32 v99, v163, v167
    v_cvt_pk_bf16_f32 v107, v177, v181
    v_cvt_pk_bf16_f32 v115, v179, v183
    s_lshl_b32 s35, s36, 10
    v_lshl_add_u32 v7, v15, 5, s35
    s_barrier
    ds_read_b128 v[48:51], v7
    ds_read_b128 v[52:55], v7 offset:16
    v_and_b32 v2, 1, v15
    v_lshrrev_b32 v3, 1, v15
    v_lshl_add_u32 v2, v2, 4, v3
    s_lshl_b32 s35, s23, 7
    s_add_u32 s35, s35, 3072
    v_lshl_add_u32 v2, v2, 2, s35
    v_lshl_add_u32 v3, v14, 6, s35
    .p2align 3
    v_pk_fma_f32 v[120:121], v[194:195], v[8:9], v[192:193] op_sel:[0,0,0] op_sel_hi:[1,0,1] neg_lo:[0,0,0] neg_hi:[0,0,0]
    v_pk_fma_f32 v[124:125], v[198:199], v[8:9], v[196:197] op_sel:[0,0,0] op_sel_hi:[1,0,1] neg_lo:[0,0,0] neg_hi:[0,0,0]
    v_pk_fma_f32 v[122:123], v[210:211], v[8:9], v[208:209] op_sel:[0,0,0] op_sel_hi:[1,0,1] neg_lo:[0,0,0] neg_hi:[0,0,0]
    v_pk_fma_f32 v[126:127], v[214:215], v[8:9], v[212:213] op_sel:[0,0,0] op_sel_hi:[1,0,1] neg_lo:[0,0,0] neg_hi:[0,0,0]
    v_pk_fma_f32 v[120:121], v[210:211], v[8:9], v[120:121] op_sel:[0,1,0] op_sel_hi:[1,1,1] neg_lo:[0,1,0] neg_hi:[0,1,0]
    v_pk_fma_f32 v[124:125], v[214:215], v[8:9], v[124:125] op_sel:[0,1,0] op_sel_hi:[1,1,1] neg_lo:[0,1,0] neg_hi:[0,1,0]
    v_pk_fma_f32 v[122:123], v[194:195], v[8:9], v[122:123] op_sel:[0,1,0] op_sel_hi:[1,1,1] neg_lo:[0,0,0] neg_hi:[0,0,0]
    v_pk_fma_f32 v[126:127], v[198:199], v[8:9], v[126:127] op_sel:[0,1,0] op_sel_hi:[1,1,1] neg_lo:[0,0,0] neg_hi:[0,0,0]
    v_pk_fma_f32 v[192:193], v[192:193], 2.0, v[120:121] op_sel:[0,0,0] op_sel_hi:[1,0,1] neg_lo:[0,0,1] neg_hi:[0,0,1]
    v_pk_fma_f32 v[196:197], v[196:197], 2.0, v[124:125] op_sel:[0,0,0] op_sel_hi:[1,0,1] neg_lo:[0,0,1] neg_hi:[0,0,1]
    v_pk_fma_f32 v[168:169], v[208:209], 2.0, v[122:123] op_sel:[0,0,0] op_sel_hi:[1,0,1] neg_lo:[0,0,1] neg_hi:[0,0,1]
    v_pk_fma_f32 v[172:173], v[212:213], 2.0, v[126:127] op_sel:[0,0,0] op_sel_hi:[1,0,1] neg_lo:[0,0,1] neg_hi:[0,0,1]
    v_pk_fma_f32 v[194:195], v[120:121], v[10:11], v[120:121] op_sel:[1,0,0] op_sel_hi:[1,0,0] neg_lo:[0,0,0] neg_hi:[0,1,0]
    v_pk_fma_f32 v[198:199], v[124:125], v[10:11], v[124:125] op_sel:[1,0,0] op_sel_hi:[1,0,0] neg_lo:[0,0,0] neg_hi:[0,1,0]
    v_pk_fma_f32 v[170:171], v[122:123], v[10:11], v[122:123] op_sel:[1,0,0] op_sel_hi:[1,0,0] neg_lo:[0,0,0] neg_hi:[0,0,1]
    v_pk_fma_f32 v[174:175], v[126:127], v[10:11], v[126:127] op_sel:[1,0,0] op_sel_hi:[1,0,0] neg_lo:[0,0,0] neg_hi:[0,0,1]
    v_pk_fma_f32 v[184:185], v[168:169], v[10:11], v[192:193] op_sel:[1,0,0] op_sel_hi:[1,0,0] neg_lo:[0,0,0] neg_hi:[0,1,0]
    v_pk_fma_f32 v[188:189], v[172:173], v[10:11], v[196:197] op_sel:[1,0,0] op_sel_hi:[1,0,0] neg_lo:[0,0,0] neg_hi:[0,1,0]
    v_pk_fma_f32 v[186:187], v[192:193], v[10:11], v[168:169] op_sel:[1,0,0] op_sel_hi:[1,0,0] neg_lo:[0,1,0] neg_hi:[0,1,1]
    v_pk_fma_f32 v[190:191], v[196:197], v[10:11], v[172:173] op_sel:[1,0,0] op_sel_hi:[1,0,0] neg_lo:[0,1,0] neg_hi:[0,1,1]
    v_pk_fma_f32 v[194:195], v[122:123], v[10:11], v[194:195] op_sel:[1,1,0] op_sel_hi:[1,1,1] neg_lo:[0,1,0] neg_hi:[0,0,0]
    v_pk_fma_f32 v[198:199], v[126:127], v[10:11], v[198:199] op_sel:[1,1,0] op_sel_hi:[1,1,1] neg_lo:[0,1,0] neg_hi:[0,0,0]
    v_pk_fma_f32 v[170:171], v[120:121], v[10:11], v[170:171] op_sel:[1,1,0] op_sel_hi:[1,1,1] neg_lo:[0,0,0] neg_hi:[0,0,0]
    v_pk_fma_f32 v[174:175], v[124:125], v[10:11], v[174:175] op_sel:[1,1,0] op_sel_hi:[1,1,1] neg_lo:[0,0,0] neg_hi:[0,0,0]
    v_pk_fma_f32 v[184:185], v[192:193], v[10:11], v[184:185] op_sel:[1,1,0] op_sel_hi:[1,1,1] neg_lo:[0,0,0] neg_hi:[0,1,0]
    v_pk_fma_f32 v[188:189], v[196:197], v[10:11], v[188:189] op_sel:[1,1,0] op_sel_hi:[1,1,1] neg_lo:[0,0,0] neg_hi:[0,1,0]
    v_pk_fma_f32 v[186:187], v[168:169], v[10:11], v[186:187] op_sel:[1,1,0] op_sel_hi:[1,1,1] neg_lo:[0,0,0] neg_hi:[0,0,0]
    v_pk_fma_f32 v[190:191], v[172:173], v[10:11], v[190:191] op_sel:[1,1,0] op_sel_hi:[1,1,1] neg_lo:[0,0,0] neg_hi:[0,0,0]
    s_mov_b64 exec, s[42:43]
    v_mov_b32 v194, v192
    v_pk_fma_f32 v[184:185], v[168:169], v[12:13], v[208:209] op_sel:[1,0,0] op_sel_hi:[1,0,0] neg_lo:[0,0,0] neg_hi:[0,1,0]
    v_pk_fma_f32 v[186:187], v[122:123], v[12:13], v[210:211] op_sel:[1,0,0] op_sel_hi:[1,0,0] neg_lo:[0,1,1] neg_hi:[0,1,0]
    v_pk_fma_f32 v[188:189], v[172:173], v[12:13], v[212:213] op_sel:[1,0,0] op_sel_hi:[1,0,0] neg_lo:[0,0,0] neg_hi:[0,1,0]
    v_pk_fma_f32 v[190:191], v[126:127], v[12:13], v[214:215] op_sel:[1,0,0] op_sel_hi:[1,0,0] neg_lo:[0,1,1] neg_hi:[0,1,0]
    v_sub_f32 v170, 0, v193
    v_mov_b32 v171, 0
    v_mov_b32 v198, v196
    v_sub_f32 v174, 0, v197
    v_mov_b32 v175, 0
    s_mov_b64 exec, -1
    v_cvt_pk_bf16_f32 v60, v194, v198
    v_cvt_pk_bf16_f32 v68, v170, v174
    v_cvt_pk_bf16_f32 v76, v184, v188
    v_cvt_pk_bf16_f32 v84, v186, v190
    v_cvt_pk_bf16_f32 v92, v195, v199
    v_cvt_pk_bf16_f32 v100, v171, v175
    v_cvt_pk_bf16_f32 v108, v185, v189
    v_cvt_pk_bf16_f32 v116, v187, v191
    v_pk_fma_f32 v[120:121], v[202:203], v[8:9], v[200:201] op_sel:[0,0,0] op_sel_hi:[1,0,1] neg_lo:[0,0,0] neg_hi:[0,0,0]
    v_pk_fma_f32 v[124:125], v[206:207], v[8:9], v[204:205] op_sel:[0,0,0] op_sel_hi:[1,0,1] neg_lo:[0,0,0] neg_hi:[0,0,0]
    v_pk_fma_f32 v[122:123], v[218:219], v[8:9], v[216:217] op_sel:[0,0,0] op_sel_hi:[1,0,1] neg_lo:[0,0,0] neg_hi:[0,0,0]
    v_pk_fma_f32 v[126:127], v[222:223], v[8:9], v[220:221] op_sel:[0,0,0] op_sel_hi:[1,0,1] neg_lo:[0,0,0] neg_hi:[0,0,0]
    v_pk_fma_f32 v[120:121], v[218:219], v[8:9], v[120:121] op_sel:[0,1,0] op_sel_hi:[1,1,1] neg_lo:[0,1,0] neg_hi:[0,1,0]
    v_pk_fma_f32 v[124:125], v[222:223], v[8:9], v[124:125] op_sel:[0,1,0] op_sel_hi:[1,1,1] neg_lo:[0,1,0] neg_hi:[0,1,0]
    v_pk_fma_f32 v[122:123], v[202:203], v[8:9], v[122:123] op_sel:[0,1,0] op_sel_hi:[1,1,1] neg_lo:[0,0,0] neg_hi:[0,0,0]
    v_pk_fma_f32 v[126:127], v[206:207], v[8:9], v[126:127] op_sel:[0,1,0] op_sel_hi:[1,1,1] neg_lo:[0,0,0] neg_hi:[0,0,0]
    v_pk_fma_f32 v[200:201], v[200:201], 2.0, v[120:121] op_sel:[0,0,0] op_sel_hi:[1,0,1] neg_lo:[0,0,1] neg_hi:[0,0,1]
    v_pk_fma_f32 v[204:205], v[204:205], 2.0, v[124:125] op_sel:[0,0,0] op_sel_hi:[1,0,1] neg_lo:[0,0,1] neg_hi:[0,0,1]
    v_pk_fma_f32 v[192:193], v[216:217], 2.0, v[122:123] op_sel:[0,0,0] op_sel_hi:[1,0,1] neg_lo:[0,0,1] neg_hi:[0,0,1]
    v_pk_fma_f32 v[196:197], v[220:221], 2.0, v[126:127] op_sel:[0,0,0] op_sel_hi:[1,0,1] neg_lo:[0,0,1] neg_hi:[0,0,1]
    v_pk_fma_f32 v[202:203], v[120:121], v[10:11], v[120:121] op_sel:[1,0,0] op_sel_hi:[1,0,0] neg_lo:[0,0,0] neg_hi:[0,1,0]
    v_pk_fma_f32 v[206:207], v[124:125], v[10:11], v[124:125] op_sel:[1,0,0] op_sel_hi:[1,0,0] neg_lo:[0,0,0] neg_hi:[0,1,0]
    v_pk_fma_f32 v[194:195], v[122:123], v[10:11], v[122:123] op_sel:[1,0,0] op_sel_hi:[1,0,0] neg_lo:[0,0,0] neg_hi:[0,0,1]
    v_pk_fma_f32 v[198:199], v[126:127], v[10:11], v[126:127] op_sel:[1,0,0] op_sel_hi:[1,0,0] neg_lo:[0,0,0] neg_hi:[0,0,1]
    v_pk_fma_f32 v[208:209], v[192:193], v[10:11], v[200:201] op_sel:[1,0,0] op_sel_hi:[1,0,0] neg_lo:[0,0,0] neg_hi:[0,1,0]
    v_pk_fma_f32 v[212:213], v[196:197], v[10:11], v[204:205] op_sel:[1,0,0] op_sel_hi:[1,0,0] neg_lo:[0,0,0] neg_hi:[0,1,0]
    v_pk_fma_f32 v[210:211], v[200:201], v[10:11], v[192:193] op_sel:[1,0,0] op_sel_hi:[1,0,0] neg_lo:[0,1,0] neg_hi:[0,1,1]
    v_pk_fma_f32 v[214:215], v[204:205], v[10:11], v[196:197] op_sel:[1,0,0] op_sel_hi:[1,0,0] neg_lo:[0,1,0] neg_hi:[0,1,1]
    v_pk_fma_f32 v[202:203], v[122:123], v[10:11], v[202:203] op_sel:[1,1,0] op_sel_hi:[1,1,1] neg_lo:[0,1,0] neg_hi:[0,0,0]
    v_pk_fma_f32 v[206:207], v[126:127], v[10:11], v[206:207] op_sel:[1,1,0] op_sel_hi:[1,1,1] neg_lo:[0,1,0] neg_hi:[0,0,0]
    v_pk_fma_f32 v[194:195], v[120:121], v[10:11], v[194:195] op_sel:[1,1,0] op_sel_hi:[1,1,1] neg_lo:[0,0,0] neg_hi:[0,0,0]
    v_pk_fma_f32 v[198:199], v[124:125], v[10:11], v[198:199] op_sel:[1,1,0] op_sel_hi:[1,1,1] neg_lo:[0,0,0] neg_hi:[0,0,0]
    v_pk_fma_f32 v[208:209], v[200:201], v[10:11], v[208:209] op_sel:[1,1,0] op_sel_hi:[1,1,1] neg_lo:[0,0,0] neg_hi:[0,1,0]
    v_pk_fma_f32 v[212:213], v[204:205], v[10:11], v[212:213] op_sel:[1,1,0] op_sel_hi:[1,1,1] neg_lo:[0,0,0] neg_hi:[0,1,0]
    v_pk_fma_f32 v[210:211], v[192:193], v[10:11], v[210:211] op_sel:[1,1,0] op_sel_hi:[1,1,1] neg_lo:[0,0,0] neg_hi:[0,0,0]
    v_pk_fma_f32 v[214:215], v[196:197], v[10:11], v[214:215] op_sel:[1,1,0] op_sel_hi:[1,1,1] neg_lo:[0,0,0] neg_hi:[0,0,0]
    s_mov_b64 exec, s[42:43]
    v_mov_b32 v202, v200
    v_pk_fma_f32 v[208:209], v[192:193], v[12:13], v[216:217] op_sel:[1,0,0] op_sel_hi:[1,0,0] neg_lo:[0,0,0] neg_hi:[0,1,0]
    v_pk_fma_f32 v[210:211], v[122:123], v[12:13], v[218:219] op_sel:[1,0,0] op_sel_hi:[1,0,0] neg_lo:[0,1,1] neg_hi:[0,1,0]
    v_pk_fma_f32 v[212:213], v[196:197], v[12:13], v[220:221] op_sel:[1,0,0] op_sel_hi:[1,0,0] neg_lo:[0,0,0] neg_hi:[0,1,0]
    v_pk_fma_f32 v[214:215], v[126:127], v[12:13], v[222:223] op_sel:[1,0,0] op_sel_hi:[1,0,0] neg_lo:[0,1,1] neg_hi:[0,1,0]
    v_sub_f32 v194, 0, v201
    v_mov_b32 v195, 0
    v_mov_b32 v206, v204
    v_sub_f32 v198, 0, v205
    v_mov_b32 v199, 0
    s_mov_b64 exec, -1
    v_cvt_pk_bf16_f32 v61, v202, v206
    v_cvt_pk_bf16_f32 v69, v194, v198
    v_cvt_pk_bf16_f32 v77, v208, v212
    v_cvt_pk_bf16_f32 v85, v210, v214
    v_cvt_pk_bf16_f32 v93, v203, v207
    v_cvt_pk_bf16_f32 v101, v195, v199
    v_cvt_pk_bf16_f32 v109, v209, v213
    v_cvt_pk_bf16_f32 v117, v211, v215
    s_waitcnt lgkmcnt(0)
    v_pk_add_f32 v[48:49], v[48:49], v[50:51]
    v_pk_add_f32 v[52:53], v[52:53], v[54:55]
    v_pk_add_f32 v[48:49], v[48:49], v[52:53]
    v_mul_f32 v48, 0x3b000000, v48
    v_mul_f32 v49, 0x3b000000, v49
    v_fma_f32 v49, -v48, v48, v49
    v_max_f32 v49, 0, v49
    v_add_f32 v49, 0x3727c5ac, v49
    v_rsq_f32 v49, v49
    s_nop 0
    ds_write_b32 v2, v49
    .p2align 3
    v_pk_fma_f32 v[120:121], v[226:227], v[8:9], v[224:225] op_sel:[0,0,0] op_sel_hi:[1,0,1] neg_lo:[0,0,0] neg_hi:[0,0,0]
    v_pk_fma_f32 v[124:125], v[230:231], v[8:9], v[228:229] op_sel:[0,0,0] op_sel_hi:[1,0,1] neg_lo:[0,0,0] neg_hi:[0,0,0]
    v_pk_fma_f32 v[122:123], v[242:243], v[8:9], v[240:241] op_sel:[0,0,0] op_sel_hi:[1,0,1] neg_lo:[0,0,0] neg_hi:[0,0,0]
    v_pk_fma_f32 v[126:127], v[246:247], v[8:9], v[244:245] op_sel:[0,0,0] op_sel_hi:[1,0,1] neg_lo:[0,0,0] neg_hi:[0,0,0]
    v_pk_fma_f32 v[120:121], v[242:243], v[8:9], v[120:121] op_sel:[0,1,0] op_sel_hi:[1,1,1] neg_lo:[0,1,0] neg_hi:[0,1,0]
    v_pk_fma_f32 v[124:125], v[246:247], v[8:9], v[124:125] op_sel:[0,1,0] op_sel_hi:[1,1,1] neg_lo:[0,1,0] neg_hi:[0,1,0]
    v_pk_fma_f32 v[122:123], v[226:227], v[8:9], v[122:123] op_sel:[0,1,0] op_sel_hi:[1,1,1] neg_lo:[0,0,0] neg_hi:[0,0,0]
    v_pk_fma_f32 v[126:127], v[230:231], v[8:9], v[126:127] op_sel:[0,1,0] op_sel_hi:[1,1,1] neg_lo:[0,0,0] neg_hi:[0,0,0]
    v_pk_fma_f32 v[224:225], v[224:225], 2.0, v[120:121] op_sel:[0,0,0] op_sel_hi:[1,0,1] neg_lo:[0,0,1] neg_hi:[0,0,1]
    v_pk_fma_f32 v[228:229], v[228:229], 2.0, v[124:125] op_sel:[0,0,0] op_sel_hi:[1,0,1] neg_lo:[0,0,1] neg_hi:[0,0,1]
    v_pk_fma_f32 v[200:201], v[240:241], 2.0, v[122:123] op_sel:[0,0,0] op_sel_hi:[1,0,1] neg_lo:[0,0,1] neg_hi:[0,0,1]
    v_pk_fma_f32 v[204:205], v[244:245], 2.0, v[126:127] op_sel:[0,0,0] op_sel_hi:[1,0,1] neg_lo:[0,0,1] neg_hi:[0,0,1]
    v_pk_fma_f32 v[226:227], v[120:121], v[10:11], v[120:121] op_sel:[1,0,0] op_sel_hi:[1,0,0] neg_lo:[0,0,0] neg_hi:[0,1,0]
    v_pk_fma_f32 v[230:231], v[124:125], v[10:11], v[124:125] op_sel:[1,0,0] op_sel_hi:[1,0,0] neg_lo:[0,0,0] neg_hi:[0,1,0]
    v_pk_fma_f32 v[202:203], v[122:123], v[10:11], v[122:123] op_sel:[1,0,0] op_sel_hi:[1,0,0] neg_lo:[0,0,0] neg_hi:[0,0,1]
    v_pk_fma_f32 v[206:207], v[126:127], v[10:11], v[126:127] op_sel:[1,0,0] op_sel_hi:[1,0,0] neg_lo:[0,0,0] neg_hi:[0,0,1]
    v_pk_fma_f32 v[216:217], v[200:201], v[10:11], v[224:225] op_sel:[1,0,0] op_sel_hi:[1,0,0] neg_lo:[0,0,0] neg_hi:[0,1,0]
    v_pk_fma_f32 v[220:221], v[204:205], v[10:11], v[228:229] op_sel:[1,0,0] op_sel_hi:[1,0,0] neg_lo:[0,0,0] neg_hi:[0,1,0]
    v_pk_fma_f32 v[218:219], v[224:225], v[10:11], v[200:201] op_sel:[1,0,0] op_sel_hi:[1,0,0] neg_lo:[0,1,0] neg_hi:[0,1,1]
    v_pk_fma_f32 v[222:223], v[228:229], v[10:11], v[204:205] op_sel:[1,0,0] op_sel_hi:[1,0,0] neg_lo:[0,1,0] neg_hi:[0,1,1]
    v_pk_fma_f32 v[226:227], v[122:123], v[10:11], v[226:227] op_sel:[1,1,0] op_sel_hi:[1,1,1] neg_lo:[0,1,0] neg_hi:[0,0,0]
    v_pk_fma_f32 v[230:231], v[126:127], v[10:11], v[230:231] op_sel:[1,1,0] op_sel_hi:[1,1,1] neg_lo:[0,1,0] neg_hi:[0,0,0]
    v_pk_fma_f32 v[202:203], v[120:121], v[10:11], v[202:203] op_sel:[1,1,0] op_sel_hi:[1,1,1] neg_lo:[0,0,0] neg_hi:[0,0,0]
    v_pk_fma_f32 v[206:207], v[124:125], v[10:11], v[206:207] op_sel:[1,1,0] op_sel_hi:[1,1,1] neg_lo:[0,0,0] neg_hi:[0,0,0]
    v_pk_fma_f32 v[216:217], v[224:225], v[10:11], v[216:217] op_sel:[1,1,0] op_sel_hi:[1,1,1] neg_lo:[0,0,0] neg_hi:[0,1,0]
    v_pk_fma_f32 v[220:221], v[228:229], v[10:11], v[220:221] op_sel:[1,1,0] op_sel_hi:[1,1,1] neg_lo:[0,0,0] neg_hi:[0,1,0]
    v_pk_fma_f32 v[218:219], v[200:201], v[10:11], v[218:219] op_sel:[1,1,0] op_sel_hi:[1,1,1] neg_lo:[0,0,0] neg_hi:[0,0,0]
    v_pk_fma_f32 v[222:223], v[204:205], v[10:11], v[222:223] op_sel:[1,1,0] op_sel_hi:[1,1,1] neg_lo:[0,0,0] neg_hi:[0,0,0]
    s_mov_b64 exec, s[42:43]
    v_mov_b32 v226, v224
    v_pk_fma_f32 v[216:217], v[200:201], v[12:13], v[240:241] op_sel:[1,0,0] op_sel_hi:[1,0,0] neg_lo:[0,0,0] neg_hi:[0,1,0]
    v_pk_fma_f32 v[218:219], v[122:123], v[12:13], v[242:243] op_sel:[1,0,0] op_sel_hi:[1,0,0] neg_lo:[0,1,1] neg_hi:[0,1,0]
    v_pk_fma_f32 v[220:221], v[204:205], v[12:13], v[244:245] op_sel:[1,0,0] op_sel_hi:[1,0,0] neg_lo:[0,0,0] neg_hi:[0,1,0]
    v_pk_fma_f32 v[222:223], v[126:127], v[12:13], v[246:247] op_sel:[1,0,0] op_sel_hi:[1,0,0] neg_lo:[0,1,1] neg_hi:[0,1,0]
    v_sub_f32 v202, 0, v225
    v_mov_b32 v203, 0
    v_mov_b32 v230, v228
    v_sub_f32 v206, 0, v229
    v_mov_b32 v207, 0
    s_mov_b64 exec, -1
    v_cvt_pk_bf16_f32 v62, v226, v230
    v_cvt_pk_bf16_f32 v70, v202, v206
    v_cvt_pk_bf16_f32 v78, v216, v220
    v_cvt_pk_bf16_f32 v86, v218, v222
    v_cvt_pk_bf16_f32 v94, v227, v231
    v_cvt_pk_bf16_f32 v102, v203, v207
    v_cvt_pk_bf16_f32 v110, v217, v221
    v_cvt_pk_bf16_f32 v118, v219, v223
    s_waitcnt lgkmcnt(0)
    ds_read_b128 v[128:131], v3
    ds_read_b128 v[132:135], v3 offset:16
    ds_read_b128 v[136:139], v3 offset:32
    ds_read_b128 v[140:143], v3 offset:48
    v_lshlrev_b32 v2, 2, v15
    v_lshl_add_u32 v2, v14, 18, v2
    .p2align 3
    v_pk_fma_f32 v[120:121], v[234:235], v[8:9], v[232:233] op_sel:[0,0,0] op_sel_hi:[1,0,1] neg_lo:[0,0,0] neg_hi:[0,0,0]
    v_pk_fma_f32 v[124:125], v[238:239], v[8:9], v[236:237] op_sel:[0,0,0] op_sel_hi:[1,0,1] neg_lo:[0,0,0] neg_hi:[0,0,0]
    v_pk_fma_f32 v[122:123], v[250:251], v[8:9], v[248:249] op_sel:[0,0,0] op_sel_hi:[1,0,1] neg_lo:[0,0,0] neg_hi:[0,0,0]
    v_pk_fma_f32 v[126:127], v[254:255], v[8:9], v[252:253] op_sel:[0,0,0] op_sel_hi:[1,0,1] neg_lo:[0,0,0] neg_hi:[0,0,0]
    v_pk_fma_f32 v[120:121], v[250:251], v[8:9], v[120:121] op_sel:[0,1,0] op_sel_hi:[1,1,1] neg_lo:[0,1,0] neg_hi:[0,1,0]
    v_pk_fma_f32 v[124:125], v[254:255], v[8:9], v[124:125] op_sel:[0,1,0] op_sel_hi:[1,1,1] neg_lo:[0,1,0] neg_hi:[0,1,0]
    v_pk_fma_f32 v[122:123], v[234:235], v[8:9], v[122:123] op_sel:[0,1,0] op_sel_hi:[1,1,1] neg_lo:[0,0,0] neg_hi:[0,0,0]
    v_pk_fma_f32 v[126:127], v[238:239], v[8:9], v[126:127] op_sel:[0,1,0] op_sel_hi:[1,1,1] neg_lo:[0,0,0] neg_hi:[0,0,0]
    v_pk_fma_f32 v[232:233], v[232:233], 2.0, v[120:121] op_sel:[0,0,0] op_sel_hi:[1,0,1] neg_lo:[0,0,1] neg_hi:[0,0,1]
    v_pk_fma_f32 v[236:237], v[236:237], 2.0, v[124:125] op_sel:[0,0,0] op_sel_hi:[1,0,1] neg_lo:[0,0,1] neg_hi:[0,0,1]
    v_pk_fma_f32 v[224:225], v[248:249], 2.0, v[122:123] op_sel:[0,0,0] op_sel_hi:[1,0,1] neg_lo:[0,0,1] neg_hi:[0,0,1]
    v_pk_fma_f32 v[228:229], v[252:253], 2.0, v[126:127] op_sel:[0,0,0] op_sel_hi:[1,0,1] neg_lo:[0,0,1] neg_hi:[0,0,1]
    v_pk_fma_f32 v[234:235], v[120:121], v[10:11], v[120:121] op_sel:[1,0,0] op_sel_hi:[1,0,0] neg_lo:[0,0,0] neg_hi:[0,1,0]
    v_pk_fma_f32 v[238:239], v[124:125], v[10:11], v[124:125] op_sel:[1,0,0] op_sel_hi:[1,0,0] neg_lo:[0,0,0] neg_hi:[0,1,0]
    v_pk_fma_f32 v[226:227], v[122:123], v[10:11], v[122:123] op_sel:[1,0,0] op_sel_hi:[1,0,0] neg_lo:[0,0,0] neg_hi:[0,0,1]
    v_pk_fma_f32 v[230:231], v[126:127], v[10:11], v[126:127] op_sel:[1,0,0] op_sel_hi:[1,0,0] neg_lo:[0,0,0] neg_hi:[0,0,1]
    v_pk_fma_f32 v[240:241], v[224:225], v[10:11], v[232:233] op_sel:[1,0,0] op_sel_hi:[1,0,0] neg_lo:[0,0,0] neg_hi:[0,1,0]
    v_pk_fma_f32 v[244:245], v[228:229], v[10:11], v[236:237] op_sel:[1,0,0] op_sel_hi:[1,0,0] neg_lo:[0,0,0] neg_hi:[0,1,0]
    v_pk_fma_f32 v[242:243], v[232:233], v[10:11], v[224:225] op_sel:[1,0,0] op_sel_hi:[1,0,0] neg_lo:[0,1,0] neg_hi:[0,1,1]
    v_pk_fma_f32 v[246:247], v[236:237], v[10:11], v[228:229] op_sel:[1,0,0] op_sel_hi:[1,0,0] neg_lo:[0,1,0] neg_hi:[0,1,1]
    v_pk_fma_f32 v[234:235], v[122:123], v[10:11], v[234:235] op_sel:[1,1,0] op_sel_hi:[1,1,1] neg_lo:[0,1,0] neg_hi:[0,0,0]
    v_pk_fma_f32 v[238:239], v[126:127], v[10:11], v[238:239] op_sel:[1,1,0] op_sel_hi:[1,1,1] neg_lo:[0,1,0] neg_hi:[0,0,0]
    v_pk_fma_f32 v[226:227], v[120:121], v[10:11], v[226:227] op_sel:[1,1,0] op_sel_hi:[1,1,1] neg_lo:[0,0,0] neg_hi:[0,0,0]
    v_pk_fma_f32 v[230:231], v[124:125], v[10:11], v[230:231] op_sel:[1,1,0] op_sel_hi:[1,1,1] neg_lo:[0,0,0] neg_hi:[0,0,0]
    v_pk_fma_f32 v[240:241], v[232:233], v[10:11], v[240:241] op_sel:[1,1,0] op_sel_hi:[1,1,1] neg_lo:[0,0,0] neg_hi:[0,1,0]
    v_pk_fma_f32 v[244:245], v[236:237], v[10:11], v[244:245] op_sel:[1,1,0] op_sel_hi:[1,1,1] neg_lo:[0,0,0] neg_hi:[0,1,0]
    v_pk_fma_f32 v[242:243], v[224:225], v[10:11], v[242:243] op_sel:[1,1,0] op_sel_hi:[1,1,1] neg_lo:[0,0,0] neg_hi:[0,0,0]
    v_pk_fma_f32 v[246:247], v[228:229], v[10:11], v[246:247] op_sel:[1,1,0] op_sel_hi:[1,1,1] neg_lo:[0,0,0] neg_hi:[0,0,0]
    s_mov_b64 exec, s[42:43]
    v_mov_b32 v234, v232
    v_pk_fma_f32 v[240:241], v[224:225], v[12:13], v[248:249] op_sel:[1,0,0] op_sel_hi:[1,0,0] neg_lo:[0,0,0] neg_hi:[0,1,0]
    v_pk_fma_f32 v[242:243], v[122:123], v[12:13], v[250:251] op_sel:[1,0,0] op_sel_hi:[1,0,0] neg_lo:[0,1,1] neg_hi:[0,1,0]
    v_pk_fma_f32 v[244:245], v[228:229], v[12:13], v[252:253] op_sel:[1,0,0] op_sel_hi:[1,0,0] neg_lo:[0,0,0] neg_hi:[0,1,0]
    v_pk_fma_f32 v[246:247], v[126:127], v[12:13], v[254:255] op_sel:[1,0,0] op_sel_hi:[1,0,0] neg_lo:[0,1,1] neg_hi:[0,1,0]
    v_sub_f32 v226, 0, v233
    v_mov_b32 v227, 0
    v_mov_b32 v238, v236
    v_sub_f32 v230, 0, v237
    v_mov_b32 v231, 0
    s_mov_b64 exec, -1
    v_cvt_pk_bf16_f32 v63, v234, v238
    v_cvt_pk_bf16_f32 v71, v226, v230
    v_cvt_pk_bf16_f32 v79, v240, v244
    v_cvt_pk_bf16_f32 v87, v242, v246
    v_cvt_pk_bf16_f32 v95, v235, v239
    v_cvt_pk_bf16_f32 v103, v227, v231
    v_cvt_pk_bf16_f32 v111, v241, v245
    v_cvt_pk_bf16_f32 v119, v243, v247
    s_waitcnt lgkmcnt(0)
    v_pk_mul_f32 v[16:17], v[16:17], v[128:129]
    v_pk_mul_f32 v[32:33], v[32:33], v[128:129]
    v_pk_mul_f32 v[18:19], v[18:19], v[130:131]
    v_pk_mul_f32 v[34:35], v[34:35], v[130:131]
    v_pk_mul_f32 v[20:21], v[20:21], v[132:133]
    v_pk_mul_f32 v[36:37], v[36:37], v[132:133]
    v_pk_mul_f32 v[22:23], v[22:23], v[134:135]
    v_pk_mul_f32 v[38:39], v[38:39], v[134:135]
    v_pk_mul_f32 v[24:25], v[24:25], v[136:137]
    v_pk_mul_f32 v[40:41], v[40:41], v[136:137]
    v_pk_mul_f32 v[26:27], v[26:27], v[138:139]
    v_pk_mul_f32 v[42:43], v[42:43], v[138:139]
    v_pk_mul_f32 v[28:29], v[28:29], v[140:141]
    v_pk_mul_f32 v[44:45], v[44:45], v[140:141]
    v_pk_mul_f32 v[30:31], v[30:31], v[142:143]
    v_pk_mul_f32 v[46:47], v[46:47], v[142:143]
    v_cvt_pk_bf16_f32 v16, v16, v17
    v_cvt_pk_bf16_f32 v32, v32, v33
    v_cvt_pk_bf16_f32 v17, v18, v19
    v_cvt_pk_bf16_f32 v33, v34, v35
    v_cvt_pk_bf16_f32 v18, v20, v21
    v_cvt_pk_bf16_f32 v34, v36, v37
    v_cvt_pk_bf16_f32 v19, v22, v23
    v_cvt_pk_bf16_f32 v35, v38, v39
    v_cvt_pk_bf16_f32 v20, v24, v25
    v_cvt_pk_bf16_f32 v36, v40, v41
    v_cvt_pk_bf16_f32 v21, v26, v27
    v_cvt_pk_bf16_f32 v37, v42, v43
    v_cvt_pk_bf16_f32 v22, v28, v29
    v_cvt_pk_bf16_f32 v38, v44, v45
    v_cvt_pk_bf16_f32 v23, v30, v31
    v_cvt_pk_bf16_f32 v39, v46, v47
    v_xor_b32 v24, 0x80008000, v32
    v_xor_b32 v25, 0x80008000, v33
    v_xor_b32 v26, 0x80008000, v34
    v_xor_b32 v27, 0x80008000, v35
    v_xor_b32 v28, 0x80008000, v36
    v_xor_b32 v29, 0x80008000, v37
    v_xor_b32 v30, 0x80008000, v38
    v_xor_b32 v31, 0x80008000, v39
    buffer_load_dword v53, off, s[88:91], 0
    s_nop 1
    v_mfma_f32_32x32x16_bf16 v[128:143], v[16:19], v[56:59], 0
    v_mfma_f32_32x32x16_bf16 v[144:159], v[24:27], v[56:59], 0
    v_mfma_f32_32x32x16_bf16 v[128:143], v[20:23], v[60:63], v[128:143]
    v_mfma_f32_32x32x16_bf16 v[144:159], v[28:31], v[60:63], v[144:159]
    v_mfma_f32_32x32x16_bf16 v[128:143], v[32:35], v[64:67], v[128:143]
    v_mfma_f32_32x32x16_bf16 v[144:159], v[16:19], v[64:67], v[144:159]
    v_mfma_f32_32x32x16_bf16 v[128:143], v[36:39], v[68:71], v[128:143]
    v_mfma_f32_32x32x16_bf16 v[144:159], v[20:23], v[68:71], v[144:159]
    v_mfma_f32_32x32x16_bf16 v[160:175], v[16:19], v[72:75], 0
    v_mfma_f32_32x32x16_bf16 v[176:191], v[24:27], v[72:75], 0
    v_mfma_f32_32x32x16_bf16 v[160:175], v[20:23], v[76:79], v[160:175]
    v_mfma_f32_32x32x16_bf16 v[176:191], v[28:31], v[76:79], v[176:191]
    s_nop 7
    v_mfma_f32_32x32x16_bf16 v[160:175], v[32:35], v[80:83], v[160:175]
    v_cvt_pk_bf16_f32 v128, v128, v144
    buffer_store_dword v128, v2, s[52:55], s60 offen sc1
    v_cvt_pk_bf16_f32 v129, v129, v145
    buffer_store_dword v129, v2, s[52:55], s61 offen sc1
    v_mfma_f32_32x32x16_bf16 v[176:191], v[16:19], v[80:83], v[176:191]
    v_cvt_pk_bf16_f32 v130, v130, v146
    buffer_store_dword v130, v2, s[52:55], s62 offen sc1
    v_cvt_pk_bf16_f32 v131, v131, v147
    buffer_store_dword v131, v2, s[52:55], s63 offen sc1
    v_mfma_f32_32x32x16_bf16 v[160:175], v[36:39], v[84:87], v[160:175]
    v_cvt_pk_bf16_f32 v132, v132, v148
    buffer_store_dword v132, v2, s[52:55], s64 offen sc1
    v_cvt_pk_bf16_f32 v133, v133, v149
    buffer_store_dword v133, v2, s[52:55], s65 offen sc1
    v_mfma_f32_32x32x16_bf16 v[176:191], v[20:23], v[84:87], v[176:191]
    v_cvt_pk_bf16_f32 v134, v134, v150
    buffer_store_dword v134, v2, s[52:55], s66 offen sc1
    v_cvt_pk_bf16_f32 v135, v135, v151
    buffer_store_dword v135, v2, s[52:55], s67 offen sc1
    v_mfma_f32_32x32x16_bf16 v[192:207], v[16:19], v[88:91], 0
    v_cvt_pk_bf16_f32 v136, v136, v152
    buffer_store_dword v136, v2, s[52:55], s68 offen sc1
    v_cvt_pk_bf16_f32 v137, v137, v153
    buffer_store_dword v137, v2, s[52:55], s69 offen sc1
    v_mfma_f32_32x32x16_bf16 v[208:223], v[24:27], v[88:91], 0
    v_cvt_pk_bf16_f32 v138, v138, v154
    buffer_store_dword v138, v2, s[52:55], s70 offen sc1
    v_cvt_pk_bf16_f32 v139, v139, v155
    buffer_store_dword v139, v2, s[52:55], s71 offen sc1
    v_mfma_f32_32x32x16_bf16 v[192:207], v[20:23], v[92:95], v[192:207]
    v_cvt_pk_bf16_f32 v140, v140, v156
    buffer_store_dword v140, v2, s[52:55], s72 offen sc1
    v_cvt_pk_bf16_f32 v141, v141, v157
    buffer_store_dword v141, v2, s[52:55], s73 offen sc1
    v_mfma_f32_32x32x16_bf16 v[208:223], v[28:31], v[92:95], v[208:223]
    v_cvt_pk_bf16_f32 v142, v142, v158
    buffer_store_dword v142, v2, s[52:55], s74 offen sc1
    v_cvt_pk_bf16_f32 v143, v143, v159
    buffer_store_dword v143, v2, s[52:55], s75 offen sc1
    v_mfma_f32_32x32x16_bf16 v[192:207], v[32:35], v[96:99], v[192:207]
    v_cvt_pk_bf16_f32 v160, v160, v176
    buffer_store_dword v160, v2, s[52:55], s60 offen offset:256 sc1
    v_cvt_pk_bf16_f32 v161, v161, v177
    buffer_store_dword v161, v2, s[52:55], s61 offen offset:256 sc1
    v_mfma_f32_32x32x16_bf16 v[208:223], v[16:19], v[96:99], v[208:223]
    v_cvt_pk_bf16_f32 v162, v162, v178
    buffer_store_dword v162, v2, s[52:55], s62 offen offset:256 sc1
    v_cvt_pk_bf16_f32 v163, v163, v179
    buffer_store_dword v163, v2, s[52:55], s63 offen offset:256 sc1
    v_mfma_f32_32x32x16_bf16 v[192:207], v[36:39], v[100:103], v[192:207]
    v_cvt_pk_bf16_f32 v164, v164, v180
    buffer_store_dword v164, v2, s[52:55], s64 offen offset:256 sc1
    v_cvt_pk_bf16_f32 v165, v165, v181
    buffer_store_dword v165, v2, s[52:55], s65 offen offset:256 sc1
    v_mfma_f32_32x32x16_bf16 v[208:223], v[20:23], v[100:103], v[208:223]
    v_cvt_pk_bf16_f32 v166, v166, v182
    buffer_store_dword v166, v2, s[52:55], s66 offen offset:256 sc1
    v_cvt_pk_bf16_f32 v167, v167, v183
    buffer_store_dword v167, v2, s[52:55], s67 offen offset:256 sc1
    v_mfma_f32_32x32x16_bf16 v[224:239], v[16:19], v[104:107], 0
    v_cvt_pk_bf16_f32 v168, v168, v184
    buffer_store_dword v168, v2, s[52:55], s68 offen offset:256 sc1
    v_cvt_pk_bf16_f32 v169, v169, v185
    buffer_store_dword v169, v2, s[52:55], s69 offen offset:256 sc1
    v_mfma_f32_32x32x16_bf16 v[240:255], v[24:27], v[104:107], 0
    v_cvt_pk_bf16_f32 v170, v170, v186
    buffer_store_dword v170, v2, s[52:55], s70 offen offset:256 sc1
    v_cvt_pk_bf16_f32 v171, v171, v187
    buffer_store_dword v171, v2, s[52:55], s71 offen offset:256 sc1
    v_mfma_f32_32x32x16_bf16 v[224:239], v[20:23], v[108:111], v[224:239]
    v_cvt_pk_bf16_f32 v172, v172, v188
    buffer_store_dword v172, v2, s[52:55], s72 offen offset:256 sc1
    v_cvt_pk_bf16_f32 v173, v173, v189
    buffer_store_dword v173, v2, s[52:55], s73 offen offset:256 sc1
    v_mfma_f32_32x32x16_bf16 v[240:255], v[28:31], v[108:111], v[240:255]
    v_cvt_pk_bf16_f32 v174, v174, v190
    buffer_store_dword v174, v2, s[52:55], s74 offen offset:256 sc1
    v_cvt_pk_bf16_f32 v175, v175, v191
    buffer_store_dword v175, v2, s[52:55], s75 offen offset:256 sc1
    s_barrier
    v_mfma_f32_32x32x16_bf16 v[224:239], v[32:35], v[112:115], v[224:239]
    v_cvt_pk_bf16_f32 v192, v192, v208
    buffer_store_dword v192, v2, s[52:55], s60 offen offset:512 sc1
    v_cvt_pk_bf16_f32 v193, v193, v209
    buffer_store_dword v193, v2, s[52:55], s61 offen offset:512 sc1
    v_cvt_pk_bf16_f32 v194, v194, v210
    buffer_store_dword v194, v2, s[52:55], s62 offen offset:512 sc1
    v_cvt_pk_bf16_f32 v195, v195, v211
    buffer_store_dword v195, v2, s[52:55], s63 offen offset:512 sc1
    v_mfma_f32_32x32x16_bf16 v[240:255], v[16:19], v[112:115], v[240:255]
    v_cvt_pk_bf16_f32 v196, v196, v212
    buffer_store_dword v196, v2, s[52:55], s64 offen offset:512 sc1
    v_cvt_pk_bf16_f32 v197, v197, v213
    buffer_store_dword v197, v2, s[52:55], s65 offen offset:512 sc1
    v_cvt_pk_bf16_f32 v198, v198, v214
    buffer_store_dword v198, v2, s[52:55], s66 offen offset:512 sc1
    v_cvt_pk_bf16_f32 v199, v199, v215
    buffer_store_dword v199, v2, s[52:55], s67 offen offset:512 sc1
    v_mfma_f32_32x32x16_bf16 v[224:239], v[36:39], v[116:119], v[224:239]
    v_cvt_pk_bf16_f32 v200, v200, v216
    buffer_store_dword v200, v2, s[52:55], s68 offen offset:512 sc1
    v_cvt_pk_bf16_f32 v201, v201, v217
    buffer_store_dword v201, v2, s[52:55], s69 offen offset:512 sc1
    v_cvt_pk_bf16_f32 v202, v202, v218
    buffer_store_dword v202, v2, s[52:55], s70 offen offset:512 sc1
    v_cvt_pk_bf16_f32 v203, v203, v219
    buffer_store_dword v203, v2, s[52:55], s71 offen offset:512 sc1
    v_mfma_f32_32x32x16_bf16 v[240:255], v[20:23], v[116:119], v[240:255]
    v_cvt_pk_bf16_f32 v204, v204, v220
    buffer_store_dword v204, v2, s[52:55], s72 offen offset:512 sc1
    v_cvt_pk_bf16_f32 v205, v205, v221
    buffer_store_dword v205, v2, s[52:55], s73 offen offset:512 sc1
    v_cvt_pk_bf16_f32 v206, v206, v222
    buffer_store_dword v206, v2, s[52:55], s74 offen offset:512 sc1
    v_cvt_pk_bf16_f32 v207, v207, v223
    buffer_store_dword v207, v2, s[52:55], s75 offen offset:512 sc1
    s_nop 3
    v_cvt_pk_bf16_f32 v224, v224, v240
    buffer_store_dword v224, v2, s[52:55], s60 offen offset:768 sc1
    v_cvt_pk_bf16_f32 v225, v225, v241
    buffer_store_dword v225, v2, s[52:55], s61 offen offset:768 sc1
    v_cvt_pk_bf16_f32 v226, v226, v242
    buffer_store_dword v226, v2, s[52:55], s62 offen offset:768 sc1
    v_cvt_pk_bf16_f32 v227, v227, v243
    buffer_store_dword v227, v2, s[52:55], s63 offen offset:768 sc1
    v_cvt_pk_bf16_f32 v228, v228, v244
    buffer_store_dword v228, v2, s[52:55], s64 offen offset:768 sc1
    v_cvt_pk_bf16_f32 v229, v229, v245
    buffer_store_dword v229, v2, s[52:55], s65 offen offset:768 sc1
    v_cvt_pk_bf16_f32 v230, v230, v246
    buffer_store_dword v230, v2, s[52:55], s66 offen offset:768 sc1
    v_cvt_pk_bf16_f32 v231, v231, v247
    buffer_store_dword v231, v2, s[52:55], s67 offen offset:768 sc1
    v_cvt_pk_bf16_f32 v232, v232, v248
    buffer_store_dword v232, v2, s[52:55], s68 offen offset:768 sc1
    v_cvt_pk_bf16_f32 v233, v233, v249
    buffer_store_dword v233, v2, s[52:55], s69 offen offset:768 sc1
    v_cvt_pk_bf16_f32 v234, v234, v250
    buffer_store_dword v234, v2, s[52:55], s70 offen offset:768 sc1
    v_cvt_pk_bf16_f32 v235, v235, v251
    buffer_store_dword v235, v2, s[52:55], s71 offen offset:768 sc1
    v_cvt_pk_bf16_f32 v236, v236, v252
    buffer_store_dword v236, v2, s[52:55], s72 offen offset:768 sc1
    v_cvt_pk_bf16_f32 v237, v237, v253
    buffer_store_dword v237, v2, s[52:55], s73 offen offset:768 sc1
    v_cvt_pk_bf16_f32 v238, v238, v254
    buffer_store_dword v238, v2, s[52:55], s74 offen offset:768 sc1
    v_cvt_pk_bf16_f32 v239, v239, v255
    buffer_store_dword v239, v2, s[52:55], s75 offen offset:768 sc1
    s_waitcnt vmcnt(0)
    v_readfirstlane_b32 s41, v53
    s_nop 3
    s_cmp_eq_u32 s41, 0
    s_cbranch_scc1 L_tslow_d
L_tok_d:
    s_mov_b64 exec, 1
    buffer_store_dword v53, off, s[52:55], s82 sc1
    s_mov_b64 exec, -1
    s_mov_b32 s82, 0x40000000
    s_lshr_b32 s82, s21, 1
    s_lshl_b32 s82, s82, 4
    s_add_u32 s82, s82, s18
    s_lshl_b32 s82, s82, 7
    s_add_u32 s82, s82, 8390400
    s_cmp_eq_u32 s20, 4
    s_cselect_b32 s82, s82, 0x40000000
    s_barrier
    s_mov_b64 exec, 1
    buffer_store_dword v53, off, s[52:55], s82 sc1
    s_mov_b64 exec, -1
    s_mov_b32 s82, 0x40000000
    s_branch L_p2c
L_tslow_s:
    s_mov_b32 s99, 0x40000
Lpoll_ts:
    s_sleep 16
    buffer_load_dword v53, off, s[88:91], 0 sc1
    s_waitcnt vmcnt(0)
    v_cmp_eq_u32 vcc, 0, v53
    s_sub_u32 s99, s99, 1
    s_nop 2
    s_cmp_eq_u64 vcc, 0
    s_cselect_b32 s98, 0, s99
    s_cmp_lg_u32 s98, 0
    s_cbranch_scc1 Lpoll_ts
    v_readfirstlane_b32 s41, v53
    s_nop 3
    s_branch L_tok_s
L_sslow:
    s_mov_b32 s99, 0x40000
Lpoll_s:
    s_sleep 8
    buffer_load_dwordx4 v[32:35], v37, s[52:55], s63 offen sc1
    s_waitcnt vmcnt(0)
    v_xor_b32 v44, s41, v33
    v_xor_b32 v45, s41, v35
    v_or_b32 v44, v44, v45
    v_cmp_ne_u32 vcc, 0, v44
    s_sub_u32 s99, s99, 1
    s_nop 2
    s_cmp_eq_u64 vcc, 0
    s_cselect_b32 s98, 0, s99
    s_cmp_lg_u32 s98, 0
    s_cbranch_scc1 Lpoll_s
    s_branch L_sok
L_gslow:
    s_mov_b32 s99, 0x40000
Lpoll_g:
    s_sleep 16
    buffer_load_dwordx2 v[28:29], v60, s[52:55], s65 offen sc1
    s_waitcnt vmcnt(0)
    v_xor_b32 v28, s41, v28
    v_xor_b32 v29, s41, v29
    v_or_b32 v28, v28, v29
    v_cmp_ne_u32 vcc, 0, v28
    s_sub_u32 s99, s99, 1
    s_nop 2
    s_cmp_eq_u64 vcc, 0
    s_cselect_b32 s98, 0, s99
    s_cmp_lg_u32 s98, 0
    s_cbranch_scc1 Lpoll_g
    s_branch L_gok
L_newtag:
    s_mov_b32 s35, 8536064
    s_mov_b64 exec, 1
    buffer_load_dword v18, off, s[52:55], s35 sc1
    s_waitcnt vmcnt(0)
    v_add_u32 v18, 1, v18
    v_max_u32 v18, 1, v18
    buffer_store_dword v18, off, s[88:91], 0 sc1
    buffer_store_dword v18, off, s[52:55], s35 sc1
    s_mov_b64 exec, -1
    s_branch L_tagdone
L_tslow_l:
    s_mov_b32 s99, 0x40000
Lpoll_tl:
    s_sleep 16
    buffer_load_dword v79, off, s[88:91], 0 sc1
    s_waitcnt vmcnt(0)
    v_cmp_eq_u32 vcc, 0, v79
    s_sub_u32 s99, s99, 1
    s_nop 2
    s_cmp_eq_u64 vcc, 0
    s_cselect_b32 s98, 0, s99
    s_cmp_lg_u32 s98, 0
    s_cbranch_scc1 Lpoll_tl
    v_readfirstlane_b32 s41, v79
    s_nop 3
    s_branch L_tok_l
L_tslow_d:
    s_mov_b32 s99, 0x40000
Lpoll_td:
    s_sleep 16
    buffer_load_dword v53, off, s[88:91], 0 sc1
    s_waitcnt vmcnt(0)
    v_cmp_eq_u32 vcc, 0, v53
    s_sub_u32 s99, s99, 1
    s_nop 2
    s_cmp_eq_u64 vcc, 0
    s_cselect_b32 s98, 0, s99
    s_cmp_lg_u32 s98, 0
    s_cbranch_scc1 Lpoll_td
    v_readfirstlane_b32 s41, v53
    s_nop 3
    s_branch L_tok_d
L_end:
    s_endpgm
    .p2align 8
    .fill 1024, 4, 0xbf810000
.section .rodata,"a"
.p2align 6
.amdhsa_kernel recurrent_scan__spectral_fnet__glu_gated_geglu__prompt_kernel
  .amdhsa_next_free_vgpr 256
  .amdhsa_next_free_sgpr 102
  .amdhsa_accum_offset 256
  .amdhsa_group_segment_fixed_size 0
  .amdhsa_kernarg_size 96
  .amdhsa_user_sgpr_count 2
  .amdhsa_user_sgpr_kernarg_segment_ptr 1
  .amdhsa_system_sgpr_workgroup_id_x 1
.end_amdhsa_kernel
```
